```python
import torch

def _softmax(x, axis=-1):
    return torch.softmax(x, dim=axis)
def _gelu(x):
    return torch.nn.functional.gelu(x, approximate="tanh")
def _silu(x):
    return torch.nn.functional.silu(x)
def _sigmoid(x):
    return torch.sigmoid(x)
def _layernorm(x, axis=-1, eps=1e-5):
    m = x.mean(dim=axis, keepdim=True)
    v = x.var(dim=axis, keepdim=True, unbiased=False)
    return (x - m) / torch.sqrt(v + eps)
def _scatter_add(tgt, idx, src, axis=0):
    return tgt.clone().index_add_(axis, idx, src)
def _segment_sum(src, seg, n):
    out = torch.zeros((n,) + src.shape[1:], dtype=src.dtype)
    return out.index_add_(0, seg, src)
def _pad(x, pw):
    flat = tuple(v for pair in reversed(pw) for v in pair)
    return torch.nn.functional.pad(x, flat)

kernel_name = 'gated_mix__mha_block_cached__dense_activation_silu__decode'

def setup_inputs():

    _w = (lambda a: (lambda t: t.to(torch.bfloat16) if t.is_floating_point() else t)(torch.as_tensor(a)))
    def _A_setup():
        B, Sq, D = 2, 1, 640
        H, Sk, Dh = 32, 4096, 128
        return {
            "x": _w((lambda *s: torch.randn(*s, dtype=torch.bfloat16) * 0.05)(B, Sq, D)),
            "k_cache": _w((lambda *s: torch.randn(*s, dtype=torch.bfloat16) * 6.4)(B, H, Sk, Dh)),
            "v_cache": _w((lambda *s: torch.randn(*s, dtype=torch.bfloat16) * 0.2)(B, H, Sk, Dh)),
            "wq": _w((lambda *s: torch.randn(*s, dtype=torch.bfloat16) * 6.4)(D, H * Dh) * (D ** -0.5)),
            "wo": _w((lambda *s: torch.randn(*s, dtype=torch.bfloat16) * 0.2)(H * Dh, D) * ((H * Dh) ** -0.5)),
        }
    _A_in = _A_setup()

    def _B_setup():
        B, S, D, F = 2, 1, 640, 1728
        return {
            "x": _w((lambda *s: torch.randn(*s, dtype=torch.bfloat16) * 0.05)(B, S, D)),
            "w1": _w((lambda *s: torch.randn(*s, dtype=torch.bfloat16) * 6.4)(D, F) * (D ** -0.5)),
            "w2": _w((lambda *s: torch.randn(*s, dtype=torch.bfloat16) * 0.05)(F, D) * (F ** -0.5)),
        }
    _B_in = _B_setup()

    return {
        "A_x": _A_in["x"],
        "A_k_cache": _A_in["k_cache"],
        "A_v_cache": _A_in["v_cache"],
        "A_wq": _A_in["wq"],
        "A_wo": _A_in["wo"],
        "B_x": _B_in["x"],
        "B_w1": _B_in["w1"],
        "B_w2": _B_in["w2"],
        "gate_w": _w((lambda *s: torch.randn(*s, dtype=torch.bfloat16) * 0.05)(640) * 16.0),
    }

def reference(A_x, A_k_cache, A_v_cache, A_wq, A_wo, B_x, B_w1, B_w2, gate_w):
    def _A_ref(x, k_cache, v_cache, wq, wo):
        B, Sq, D = x.shape
        H, Dh = 32, 128
        q = (lambda x, *d: x.permute(*d))((x @ wq).reshape(B, Sq, H, Dh), 0, 2, 1, 3)
        scores = torch.einsum("bhqd,bhkd->bhqk", q, k_cache) * (Dh ** -0.5)
        p = _softmax(scores, axis=-1)
        o = torch.einsum("bhqk,bhkd->bhqd", p, v_cache)
        return (lambda x, *d: x.permute(*d))(o, 0, 2, 1, 3).reshape(B, Sq, H * Dh) @ wo

    def _B_ref(x, w1, w2):
        h = torch.einsum("bsd,df->bsf", x, w1)
        h = _silu(h)
        out = torch.einsum("bsf,fd->bsd", h, w2)
        return out

    x = A_x
    g = _sigmoid((x * gate_w).sum(-1, keepdims=True))
    a = _A_ref(x, A_k_cache, A_v_cache, A_wq, A_wo)
    b = _B_ref(x, B_w1, B_w2)
    return g * a + (1 - g) * b
```

```asm
; @launch grid=(256,1,1) block=(512,1,1) lds=24576
.amdgcn_target "amdgcn-amd-amdhsa--gfx950"
.text
.globl gated_mix__mha_block_cached__dense_activation_silu__decode_kernel
.p2align 8
.type gated_mix__mha_block_cached__dense_activation_silu__decode_kernel,@function
gated_mix__mha_block_cached__dense_activation_silu__decode_kernel:
    s_cmp_ge_u32 s2, 256
    s_cbranch_scc1 L_end
    s_load_dwordx16 s[16:31], s[0:1], 0
    s_load_dwordx8 s[32:39], s[0:1], 64
    s_and_b32 s3, s2, 7
    s_lshl_b32 s3, s3, 2
    s_lshr_b32 s4, s2, 3
    s_and_b32 s4, s4, 3
    s_add_u32 s3, s3, s4
    s_lshr_b32 s5, s2, 5
    s_lshr_b32 s6, s5, 2
    s_and_b32 s7, s5, 3
    v_lshrrev_b32 v20, 6, v0
    v_and_b32 v1, 63, v0
    v_readfirstlane_b32 s8, v20
    v_and_b32 v2, 15, v1
    v_lshlrev_b32 v2, 4, v2
    v_lshrrev_b32 v3, 4, v1
    v_lshlrev_b32 v4, 4, v1
    v_lshl_add_u32 v5, v3, 13, v2
    v_and_b32 v20, 15, v1
    v_lshl_add_u32 v20, v20, 2, v3
    v_lshlrev_b32 v20, 1, v20
    s_mov_b32 s12, 1035273459
    s_mov_b32 s13, 1069066811
    s_waitcnt lgkmcnt(0)
    s_mov_b32 s40, s18
    s_and_b32 s41, s19, 0xffff
    s_mov_b32 s42, 67108864
    s_mov_b32 s43, 0x00020000
    s_mov_b32 s44, s20
    s_and_b32 s45, s21, 0xffff
    s_mov_b32 s46, 67108864
    s_mov_b32 s47, 0x00020000
    s_mov_b32 s48, s22
    s_and_b32 s49, s23, 0xffff
    s_mov_b32 s50, 5242880
    s_mov_b32 s51, 0x00020000
    s_mov_b32 s52, s16
    s_and_b32 s53, s17, 0xffff
    s_mov_b32 s54, 2560
    s_mov_b32 s55, 0x00020000
    s_mov_b32 s56, s38
    s_and_b32 s57, s39, 0xffff
    s_mov_b32 s58, 2097152
    s_mov_b32 s59, 0x00020000
    s_mov_b32 s60, s28
    s_and_b32 s61, s29, 0xffff
    s_mov_b32 s62, 2211840
    s_mov_b32 s63, 0x00020000
    s_mov_b32 s64, s36
    s_and_b32 s65, s37, 0xffff
    s_mov_b32 s66, 256
    s_mov_b32 s67, 0x00020000
    s_mov_b32 s72, s32
    s_and_b32 s73, s33, 0xffff
    s_mov_b32 s74, 1280
    s_mov_b32 s75, 0x00020000
    s_mov_b32 s76, s34
    s_and_b32 s77, s35, 0xffff
    s_mov_b32 s78, 2560
    s_mov_b32 s79, 0x00020000
    s_lshl_b32 s9, s6, 5
    s_add_u32 s9, s9, s3
    s_lshl_b32 s9, s9, 20
    s_lshl_b32 s10, s7, 18
    s_add_u32 s9, s9, s10
    s_lshl_b32 s10, s8, 15
    s_add_u32 s9, s9, s10
    v_lshrrev_b32 v20, 1, v1
    v_and_b32 v21, 1, v1
    s_cmp_lg_u32 s8, 7
    s_cbranch_scc1 L_qld
    s_memrealtime s[100:101]
    s_waitcnt lgkmcnt(0)
    s_or_b32 s100, s100, 1
    v_mov_b32 v6, s100
    v_mov_b32 v7, 0
    v_mov_b32 v22, 0
    s_movk_i32 s11, 240
    s_mov_b64 exec, 1
    buffer_atomic_cmpswap v[6:7], v22, s[64:67], s11 offen sc0 sc1
    s_mov_b64 exec, -1
    s_waitcnt vmcnt(0)
    v_readfirstlane_b32 s101, v6
    s_cmp_eq_u32 s101, 0
    s_cselect_b32 s101, s100, s101
    v_mov_b32 v6, s101
    v_mov_b32 v22, 20480
    ds_write_b32 v22, v6
    v_mov_b32 v56, 0
    v_mov_b32 v57, 0
    v_mov_b32 v58, 0
    v_mov_b32 v59, 0
    v_mov_b32 v60, 0
    v_mov_b32 v61, 0
    v_mov_b32 v64, 0
    v_mov_b32 v65, 0
    v_mov_b32 v66, 0
    v_mov_b32 v67, 0
    v_mov_b32 v68, 0
    v_mov_b32 v69, 0
    v_mov_b32 v70, 0
    v_mov_b32 v71, 0
    v_mov_b32 v72, 0
    v_mov_b32 v73, 0
    v_mov_b32 v74, 0
    v_mov_b32 v75, 0
    s_branch L_kld
L_qld:
    v_lshlrev_b32 v22, 13, v20
    v_lshl_add_u32 v22, v21, 4, v22
    v_lshlrev_b32 v23, 1, v20
    s_lshl_b32 s10, s8, 6
    buffer_load_ushort v56, v23, s[52:55], s10 offen offset:0
    buffer_load_ushort v57, v23, s[52:55], s10 offen offset:1280
    buffer_load_ushort v58, v23, s[52:55], s10 offen offset:448
    buffer_load_ushort v59, v23, s[52:55], s10 offen offset:1728
    buffer_load_ushort v60, v23, s[52:55], s10 offen offset:896
    buffer_load_ushort v61, v23, s[52:55], s10 offen offset:2176
    s_lshl_b32 s10, s8, 18
    s_lshl_b32 s11, s3, 8
    s_add_u32 s10, s10, s11
    s_lshl_b32 s11, s5, 5
    s_add_u32 s10, s10, s11
    buffer_load_dwordx4 v[64:67], v22, s[48:51], s10 offen nt
    s_add_u32 s10, s10, 1835008
    buffer_load_dwordx4 v[68:71], v22, s[48:51], s10 offen nt
    s_add_u32 s10, s10, 1835008
    buffer_load_dwordx4 v[72:75], v22, s[48:51], s10 offen nt
L_kld:
    s_mul_i32 s83, s8, 5
    s_mul_i32 s10, s2, 3
    s_add_u32 s83, s83, s10
    s_lshl_b32 s83, s83, 10
    s_add_u32 s10, s83, 0
    s_and_b32 s10, s10, 0x7fff
    s_add_u32 s10, s10, s9
    buffer_load_dwordx4 v[112:115], v4, s[40:43], s10 offen nt
    s_add_u32 s10, s83, 1024
    s_and_b32 s10, s10, 0x7fff
    s_add_u32 s10, s10, s9
    buffer_load_dwordx4 v[116:119], v4, s[40:43], s10 offen nt
    s_add_u32 s10, s83, 2048
    s_and_b32 s10, s10, 0x7fff
    s_add_u32 s10, s10, s9
    buffer_load_dwordx4 v[120:123], v4, s[40:43], s10 offen nt
    s_add_u32 s10, s83, 3072
    s_and_b32 s10, s10, 0x7fff
    s_add_u32 s10, s10, s9
    buffer_load_dwordx4 v[124:127], v4, s[40:43], s10 offen nt
    s_add_u32 s10, s83, 4096
    s_and_b32 s10, s10, 0x7fff
    s_add_u32 s10, s10, s9
    buffer_load_dwordx4 v[128:131], v4, s[40:43], s10 offen nt
    s_add_u32 s10, s83, 5120
    s_and_b32 s10, s10, 0x7fff
    s_add_u32 s10, s10, s9
    buffer_load_dwordx4 v[132:135], v4, s[40:43], s10 offen nt
    s_add_u32 s10, s83, 6144
    s_and_b32 s10, s10, 0x7fff
    s_add_u32 s10, s10, s9
    buffer_load_dwordx4 v[136:139], v4, s[40:43], s10 offen nt
    s_add_u32 s10, s83, 7168
    s_and_b32 s10, s10, 0x7fff
    s_add_u32 s10, s10, s9
    buffer_load_dwordx4 v[140:143], v4, s[40:43], s10 offen nt
    s_cmp_ge_u32 s2, 160
    s_cbranch_scc1 L_rw2
    s_mov_b32 s68, s24
    s_and_b32 s69, s25, 0xffff
    s_mov_b32 s70, 5242880
    s_mov_b32 s71, 0x00020000
    s_mul_i32 s80, s2, 6554
    s_lshr_b32 s80, s80, 16
    s_mul_i32 s81, s80, 10
    s_sub_u32 s81, s2, s81
    s_lshl_b32 s82, s80, 8
    s_branch L_rdone
L_rw2:
    s_mov_b32 s68, s30
    s_and_b32 s69, s31, 0xffff
    s_mov_b32 s70, 2211840
    s_mov_b32 s71, 0x00020000
    s_sub_u32 s81, s2, 160
    s_mul_i32 s80, s81, 6554
    s_lshr_b32 s80, s80, 16
    s_mul_i32 s82, s80, 10
    s_sub_u32 s81, s81, s82
    s_mul_i32 s82, s80, 192
    s_add_u32 s80, s80, 16
L_rdone:
    v_mov_b32 v32, 0
    v_mov_b32 v33, 0
    v_mov_b32 v34, 0
    v_mov_b32 v35, 0
    v_mov_b32 v36, 0
    v_mov_b32 v37, 0
    v_mov_b32 v38, 0
    v_mov_b32 v39, 0
    v_mov_b32 v40, 0
    v_mov_b32 v41, 0
    v_mov_b32 v42, 0
    v_mov_b32 v43, 0
    v_mov_b32 v44, 0
    v_mov_b32 v45, 0
    v_mov_b32 v46, 0
    v_mov_b32 v47, 0
    s_waitcnt vmcnt(8)
    v_lshlrev_b32 v56, 16, v56
    v_lshlrev_b32 v57, 16, v57
    v_lshlrev_b32 v58, 16, v58
    v_lshlrev_b32 v59, 16, v59
    v_lshlrev_b32 v60, 16, v60
    v_lshlrev_b32 v61, 16, v61
    v_lshlrev_b32 v22, 16, v64
    v_and_b32 v23, 0xffff0000, v64
    v_fmac_f32 v32, v56, v22
    v_fmac_f32 v33, v56, v23
    v_fmac_f32 v40, v57, v22
    v_fmac_f32 v41, v57, v23
    v_lshlrev_b32 v22, 16, v65
    v_and_b32 v23, 0xffff0000, v65
    v_fmac_f32 v34, v56, v22
    v_fmac_f32 v35, v56, v23
    v_fmac_f32 v42, v57, v22
    v_fmac_f32 v43, v57, v23
    v_lshlrev_b32 v22, 16, v66
    v_and_b32 v23, 0xffff0000, v66
    v_fmac_f32 v36, v56, v22
    v_fmac_f32 v37, v56, v23
    v_fmac_f32 v44, v57, v22
    v_fmac_f32 v45, v57, v23
    v_lshlrev_b32 v22, 16, v67
    v_and_b32 v23, 0xffff0000, v67
    v_fmac_f32 v38, v56, v22
    v_fmac_f32 v39, v56, v23
    v_fmac_f32 v46, v57, v22
    v_fmac_f32 v47, v57, v23
    v_lshlrev_b32 v22, 16, v68
    v_and_b32 v23, 0xffff0000, v68
    v_fmac_f32 v32, v58, v22
    v_fmac_f32 v33, v58, v23
    v_fmac_f32 v40, v59, v22
    v_fmac_f32 v41, v59, v23
    v_lshlrev_b32 v22, 16, v69
    v_and_b32 v23, 0xffff0000, v69
    v_fmac_f32 v34, v58, v22
    v_fmac_f32 v35, v58, v23
    v_fmac_f32 v42, v59, v22
    v_fmac_f32 v43, v59, v23
    v_lshlrev_b32 v22, 16, v70
    v_and_b32 v23, 0xffff0000, v70
    v_fmac_f32 v36, v58, v22
    v_fmac_f32 v37, v58, v23
    v_fmac_f32 v44, v59, v22
    v_fmac_f32 v45, v59, v23
    v_lshlrev_b32 v22, 16, v71
    v_and_b32 v23, 0xffff0000, v71
    v_fmac_f32 v38, v58, v22
    v_fmac_f32 v39, v58, v23
    v_fmac_f32 v46, v59, v22
    v_fmac_f32 v47, v59, v23
    v_lshlrev_b32 v22, 16, v72
    v_and_b32 v23, 0xffff0000, v72
    v_fmac_f32 v32, v60, v22
    v_fmac_f32 v33, v60, v23
    v_fmac_f32 v40, v61, v22
    v_fmac_f32 v41, v61, v23
    v_lshlrev_b32 v22, 16, v73
    v_and_b32 v23, 0xffff0000, v73
    v_fmac_f32 v34, v60, v22
    v_fmac_f32 v35, v60, v23
    v_fmac_f32 v42, v61, v22
    v_fmac_f32 v43, v61, v23
    v_lshlrev_b32 v22, 16, v74
    v_and_b32 v23, 0xffff0000, v74
    v_fmac_f32 v36, v60, v22
    v_fmac_f32 v37, v60, v23
    v_fmac_f32 v44, v61, v22
    v_fmac_f32 v45, v61, v23
    v_lshlrev_b32 v22, 16, v75
    v_and_b32 v23, 0xffff0000, v75
    v_fmac_f32 v38, v60, v22
    v_fmac_f32 v39, v60, v23
    v_fmac_f32 v46, v61, v22
    v_fmac_f32 v47, v61, v23
    s_nop 1
    v_add_f32_dpp v32, v32, v32 row_ror:2 row_mask:0xf bank_mask:0xf
    v_add_f32_dpp v33, v33, v33 row_ror:2 row_mask:0xf bank_mask:0xf
    v_add_f32_dpp v34, v34, v34 row_ror:2 row_mask:0xf bank_mask:0xf
    v_add_f32_dpp v35, v35, v35 row_ror:2 row_mask:0xf bank_mask:0xf
    v_add_f32_dpp v36, v36, v36 row_ror:2 row_mask:0xf bank_mask:0xf
    v_add_f32_dpp v37, v37, v37 row_ror:2 row_mask:0xf bank_mask:0xf
    v_add_f32_dpp v38, v38, v38 row_ror:2 row_mask:0xf bank_mask:0xf
    v_add_f32_dpp v39, v39, v39 row_ror:2 row_mask:0xf bank_mask:0xf
    v_add_f32_dpp v40, v40, v40 row_ror:2 row_mask:0xf bank_mask:0xf
    v_add_f32_dpp v41, v41, v41 row_ror:2 row_mask:0xf bank_mask:0xf
    v_add_f32_dpp v42, v42, v42 row_ror:2 row_mask:0xf bank_mask:0xf
    v_add_f32_dpp v43, v43, v43 row_ror:2 row_mask:0xf bank_mask:0xf
    v_add_f32_dpp v44, v44, v44 row_ror:2 row_mask:0xf bank_mask:0xf
    v_add_f32_dpp v45, v45, v45 row_ror:2 row_mask:0xf bank_mask:0xf
    v_add_f32_dpp v46, v46, v46 row_ror:2 row_mask:0xf bank_mask:0xf
    v_add_f32_dpp v47, v47, v47 row_ror:2 row_mask:0xf bank_mask:0xf
    v_add_f32_dpp v32, v32, v32 row_ror:4 row_mask:0xf bank_mask:0xf
    v_add_f32_dpp v33, v33, v33 row_ror:4 row_mask:0xf bank_mask:0xf
    v_add_f32_dpp v34, v34, v34 row_ror:4 row_mask:0xf bank_mask:0xf
    v_add_f32_dpp v35, v35, v35 row_ror:4 row_mask:0xf bank_mask:0xf
    v_add_f32_dpp v36, v36, v36 row_ror:4 row_mask:0xf bank_mask:0xf
    v_add_f32_dpp v37, v37, v37 row_ror:4 row_mask:0xf bank_mask:0xf
    v_add_f32_dpp v38, v38, v38 row_ror:4 row_mask:0xf bank_mask:0xf
    v_add_f32_dpp v39, v39, v39 row_ror:4 row_mask:0xf bank_mask:0xf
    v_add_f32_dpp v40, v40, v40 row_ror:4 row_mask:0xf bank_mask:0xf
    v_add_f32_dpp v41, v41, v41 row_ror:4 row_mask:0xf bank_mask:0xf
    v_add_f32_dpp v42, v42, v42 row_ror:4 row_mask:0xf bank_mask:0xf
    v_add_f32_dpp v43, v43, v43 row_ror:4 row_mask:0xf bank_mask:0xf
    v_add_f32_dpp v44, v44, v44 row_ror:4 row_mask:0xf bank_mask:0xf
    v_add_f32_dpp v45, v45, v45 row_ror:4 row_mask:0xf bank_mask:0xf
    v_add_f32_dpp v46, v46, v46 row_ror:4 row_mask:0xf bank_mask:0xf
    v_add_f32_dpp v47, v47, v47 row_ror:4 row_mask:0xf bank_mask:0xf
    v_add_f32_dpp v32, v32, v32 row_ror:8 row_mask:0xf bank_mask:0xf
    v_add_f32_dpp v33, v33, v33 row_ror:8 row_mask:0xf bank_mask:0xf
    v_add_f32_dpp v34, v34, v34 row_ror:8 row_mask:0xf bank_mask:0xf
    v_add_f32_dpp v35, v35, v35 row_ror:8 row_mask:0xf bank_mask:0xf
    v_add_f32_dpp v36, v36, v36 row_ror:8 row_mask:0xf bank_mask:0xf
    v_add_f32_dpp v37, v37, v37 row_ror:8 row_mask:0xf bank_mask:0xf
    v_add_f32_dpp v38, v38, v38 row_ror:8 row_mask:0xf bank_mask:0xf
    v_add_f32_dpp v39, v39, v39 row_ror:8 row_mask:0xf bank_mask:0xf
    v_add_f32_dpp v40, v40, v40 row_ror:8 row_mask:0xf bank_mask:0xf
    v_add_f32_dpp v41, v41, v41 row_ror:8 row_mask:0xf bank_mask:0xf
    v_add_f32_dpp v42, v42, v42 row_ror:8 row_mask:0xf bank_mask:0xf
    v_add_f32_dpp v43, v43, v43 row_ror:8 row_mask:0xf bank_mask:0xf
    v_add_f32_dpp v44, v44, v44 row_ror:8 row_mask:0xf bank_mask:0xf
    v_add_f32_dpp v45, v45, v45 row_ror:8 row_mask:0xf bank_mask:0xf
    v_add_f32_dpp v46, v46, v46 row_ror:8 row_mask:0xf bank_mask:0xf
    v_add_f32_dpp v47, v47, v47 row_ror:8 row_mask:0xf bank_mask:0xf
    v_mov_b32 v76, v32
    v_mov_b32 v77, v33
    v_mov_b32 v78, v34
    v_mov_b32 v79, v35
    v_mov_b32 v80, v36
    v_mov_b32 v81, v37
    v_mov_b32 v82, v38
    v_mov_b32 v83, v39
    v_mov_b32 v84, v40
    v_mov_b32 v85, v41
    v_mov_b32 v86, v42
    v_mov_b32 v87, v43
    v_mov_b32 v88, v44
    v_mov_b32 v89, v45
    v_mov_b32 v90, v46
    v_mov_b32 v91, v47
    s_nop 1
    v_permlane16_swap_b32 v32, v76
    v_permlane16_swap_b32 v33, v77
    v_permlane16_swap_b32 v34, v78
    v_permlane16_swap_b32 v35, v79
    v_permlane16_swap_b32 v36, v80
    v_permlane16_swap_b32 v37, v81
    v_permlane16_swap_b32 v38, v82
    v_permlane16_swap_b32 v39, v83
    v_permlane16_swap_b32 v40, v84
    v_permlane16_swap_b32 v41, v85
    v_permlane16_swap_b32 v42, v86
    v_permlane16_swap_b32 v43, v87
    v_permlane16_swap_b32 v44, v88
    v_permlane16_swap_b32 v45, v89
    v_permlane16_swap_b32 v46, v90
    v_permlane16_swap_b32 v47, v91
    s_nop 1
    v_add_f32 v32, v32, v76
    v_add_f32 v33, v33, v77
    v_add_f32 v34, v34, v78
    v_add_f32 v35, v35, v79
    v_add_f32 v36, v36, v80
    v_add_f32 v37, v37, v81
    v_add_f32 v38, v38, v82
    v_add_f32 v39, v39, v83
    v_add_f32 v40, v40, v84
    v_add_f32 v41, v41, v85
    v_add_f32 v42, v42, v86
    v_add_f32 v43, v43, v87
    v_add_f32 v44, v44, v88
    v_add_f32 v45, v45, v89
    v_add_f32 v46, v46, v90
    v_add_f32 v47, v47, v91
    v_mov_b32 v76, v32
    v_mov_b32 v77, v33
    v_mov_b32 v78, v34
    v_mov_b32 v79, v35
    v_mov_b32 v80, v36
    v_mov_b32 v81, v37
    v_mov_b32 v82, v38
    v_mov_b32 v83, v39
    v_mov_b32 v84, v40
    v_mov_b32 v85, v41
    v_mov_b32 v86, v42
    v_mov_b32 v87, v43
    v_mov_b32 v88, v44
    v_mov_b32 v89, v45
    v_mov_b32 v90, v46
    v_mov_b32 v91, v47
    s_nop 1
    v_permlane32_swap_b32 v32, v76
    v_permlane32_swap_b32 v33, v77
    v_permlane32_swap_b32 v34, v78
    v_permlane32_swap_b32 v35, v79
    v_permlane32_swap_b32 v36, v80
    v_permlane32_swap_b32 v37, v81
    v_permlane32_swap_b32 v38, v82
    v_permlane32_swap_b32 v39, v83
    v_permlane32_swap_b32 v40, v84
    v_permlane32_swap_b32 v41, v85
    v_permlane32_swap_b32 v42, v86
    v_permlane32_swap_b32 v43, v87
    v_permlane32_swap_b32 v44, v88
    v_permlane32_swap_b32 v45, v89
    v_permlane32_swap_b32 v46, v90
    v_permlane32_swap_b32 v47, v91
    s_nop 1
    v_add_f32 v32, v32, v76
    v_add_f32 v33, v33, v77
    v_add_f32 v34, v34, v78
    v_add_f32 v35, v35, v79
    v_add_f32 v36, v36, v80
    v_add_f32 v37, v37, v81
    v_add_f32 v38, v38, v82
    v_add_f32 v39, v39, v83
    v_add_f32 v40, v40, v84
    v_add_f32 v41, v41, v85
    v_add_f32 v42, v42, v86
    v_add_f32 v43, v43, v87
    v_add_f32 v44, v44, v88
    v_add_f32 v45, v45, v89
    v_add_f32 v46, v46, v90
    v_add_f32 v47, v47, v91
    v_lshlrev_b32 v22, 6, v21
    s_lshl_b32 s10, s8, 7
    v_add_u32 v22, s10, v22
    ds_write_b128 v22, v[32:35] offset:12288
    ds_write_b128 v22, v[36:39] offset:12304
    ds_write_b128 v22, v[40:43] offset:12320
    ds_write_b128 v22, v[44:47] offset:12336
    s_waitcnt lgkmcnt(0)
    s_barrier
    s_cmp_lg_u32 s8, 0
    s_cbranch_scc1 L_q1b
    v_mov_b32 v22, 20480
    ds_read_b32 v23, v22
    s_waitcnt lgkmcnt(0)
    v_readfirstlane_b32 s101, v23
    v_lshrrev_b32 v20, 4, v1
    v_and_b32 v20, 1, v20
    v_and_b32 v21, 15, v1
    v_lshrrev_b32 v22, 3, v21
    v_lshlrev_b32 v22, 6, v22
    v_lshl_add_u32 v22, v20, 5, v22
    v_and_b32 v23, 7, v21
    v_lshl_add_u32 v22, v23, 2, v22
    ds_read_b32 v32, v22 offset:12288
    ds_read_b32 v33, v22 offset:12416
    ds_read_b32 v34, v22 offset:12544
    ds_read_b32 v35, v22 offset:12672
    ds_read_b32 v36, v22 offset:12800
    ds_read_b32 v37, v22 offset:12928
    ds_read_b32 v38, v22 offset:13056
    ds_read_b32 v39, v22 offset:13184
    s_waitcnt lgkmcnt(0)
    v_add_f32 v32, v32, v33
    v_add_f32 v32, v32, v34
    v_add_f32 v32, v32, v35
    v_add_f32 v32, v32, v36
    v_add_f32 v32, v32, v37
    v_add_f32 v32, v32, v38
    v_add_f32 v32, v32, v39
    s_nop 1
    v_mov_b32_dpp v33, v32 quad_perm:[1,0,3,2] row_mask:0xf bank_mask:0xf
    v_cvt_pk_bf16_f32 v34, v32, v33
    v_mov_b32 v35, s101
    v_lshlrev_b32 v22, 9, v20
    v_lshrrev_b32 v23, 1, v21
    v_lshl_add_u32 v22, v23, 3, v22
    s_lshl_b32 s10, s3, 10
    s_lshl_b32 s11, s5, 6
    s_add_u32 s10, s10, s11
    s_add_u32 s10, s10, 327680
    s_mov_b32 exec_lo, 0x55555555
    s_mov_b32 exec_hi, 0
    buffer_store_dwordx2 v[34:35], v22, s[56:59], s10 offen sc1
    s_mov_b64 exec, -1
L_q1b:
    s_barrier
    s_add_u32 s10, s83, 8192
    s_and_b32 s10, s10, 0x7fff
    s_add_u32 s10, s10, s9
    buffer_load_dwordx4 v[144:147], v4, s[40:43], s10 offen nt
    s_add_u32 s10, s83, 9216
    s_and_b32 s10, s10, 0x7fff
    s_add_u32 s10, s10, s9
    buffer_load_dwordx4 v[148:151], v4, s[40:43], s10 offen nt
    s_add_u32 s10, s83, 10240
    s_and_b32 s10, s10, 0x7fff
    s_add_u32 s10, s10, s9
    buffer_load_dwordx4 v[152:155], v4, s[40:43], s10 offen nt
    s_add_u32 s10, s83, 11264
    s_and_b32 s10, s10, 0x7fff
    s_add_u32 s10, s10, s9
    buffer_load_dwordx4 v[156:159], v4, s[40:43], s10 offen nt
    s_add_u32 s10, s83, 12288
    s_and_b32 s10, s10, 0x7fff
    s_add_u32 s10, s10, s9
    buffer_load_dwordx4 v[160:163], v4, s[40:43], s10 offen nt
    s_add_u32 s10, s83, 13312
    s_and_b32 s10, s10, 0x7fff
    s_add_u32 s10, s10, s9
    buffer_load_dwordx4 v[164:167], v4, s[40:43], s10 offen nt
    s_add_u32 s10, s83, 14336
    s_and_b32 s10, s10, 0x7fff
    s_add_u32 s10, s10, s9
    buffer_load_dwordx4 v[168:171], v4, s[40:43], s10 offen nt
    s_add_u32 s10, s83, 15360
    s_and_b32 s10, s10, 0x7fff
    s_add_u32 s10, s10, s9
    buffer_load_dwordx4 v[172:175], v4, s[40:43], s10 offen nt
    s_add_u32 s10, s83, 16384
    s_and_b32 s10, s10, 0x7fff
    s_add_u32 s10, s10, s9
    buffer_load_dwordx4 v[176:179], v4, s[40:43], s10 offen nt
    s_add_u32 s10, s83, 17408
    s_and_b32 s10, s10, 0x7fff
    s_add_u32 s10, s10, s9
    buffer_load_dwordx4 v[180:183], v4, s[40:43], s10 offen nt
    s_add_u32 s10, s83, 18432
    s_and_b32 s10, s10, 0x7fff
    s_add_u32 s10, s10, s9
    buffer_load_dwordx4 v[184:187], v4, s[40:43], s10 offen nt
    s_add_u32 s10, s83, 19456
    s_and_b32 s10, s10, 0x7fff
    s_add_u32 s10, s10, s9
    buffer_load_dwordx4 v[188:191], v4, s[40:43], s10 offen nt
    s_add_u32 s10, s83, 20480
    s_and_b32 s10, s10, 0x7fff
    s_add_u32 s10, s10, s9
    buffer_load_dwordx4 v[192:195], v4, s[40:43], s10 offen nt
    s_add_u32 s10, s83, 21504
    s_and_b32 s10, s10, 0x7fff
    s_add_u32 s10, s10, s9
    buffer_load_dwordx4 v[196:199], v4, s[40:43], s10 offen nt
    s_add_u32 s10, s83, 22528
    s_and_b32 s10, s10, 0x7fff
    s_add_u32 s10, s10, s9
    buffer_load_dwordx4 v[200:203], v4, s[40:43], s10 offen nt
    s_add_u32 s10, s83, 23552
    s_and_b32 s10, s10, 0x7fff
    s_add_u32 s10, s10, s9
    buffer_load_dwordx4 v[204:207], v4, s[40:43], s10 offen nt
    s_add_u32 s10, s83, 24576
    s_and_b32 s10, s10, 0x7fff
    s_add_u32 s10, s10, s9
    buffer_load_dwordx4 v[208:211], v4, s[40:43], s10 offen nt
    s_add_u32 s10, s83, 25600
    s_and_b32 s10, s10, 0x7fff
    s_add_u32 s10, s10, s9
    buffer_load_dwordx4 v[212:215], v4, s[40:43], s10 offen nt
    s_add_u32 s10, s83, 26624
    s_and_b32 s10, s10, 0x7fff
    s_add_u32 s10, s10, s9
    buffer_load_dwordx4 v[216:219], v4, s[40:43], s10 offen nt
    s_add_u32 s10, s83, 27648
    s_and_b32 s10, s10, 0x7fff
    s_add_u32 s10, s10, s9
    buffer_load_dwordx4 v[220:223], v4, s[40:43], s10 offen nt
    s_add_u32 s10, s83, 28672
    s_and_b32 s10, s10, 0x7fff
    s_add_u32 s10, s10, s9
    buffer_load_dwordx4 v[224:227], v4, s[40:43], s10 offen nt
    s_add_u32 s10, s83, 29696
    s_and_b32 s10, s10, 0x7fff
    s_add_u32 s10, s10, s9
    buffer_load_dwordx4 v[228:231], v4, s[40:43], s10 offen nt
    s_add_u32 s10, s83, 30720
    s_and_b32 s10, s10, 0x7fff
    s_add_u32 s10, s10, s9
    buffer_load_dwordx4 v[232:235], v4, s[40:43], s10 offen nt
    s_add_u32 s10, s83, 31744
    s_and_b32 s10, s10, 0x7fff
    s_add_u32 s10, s10, s9
    buffer_load_dwordx4 v[236:239], v4, s[40:43], s10 offen nt
    s_cmp_lg_u32 s8, 0
    s_cbranch_scc1 L_qwait
    s_lshl_b32 s10, s3, 1
    s_add_u32 s10, s10, s6
    s_lshl_b32 s10, s10, 9
    s_add_u32 s10, s10, 327680
    s_mov_b32 s15, 0
L_qc0:
    s_load_dwordx16 s[16:31], s[38:39], s10 glc
    s_add_u32 s11, s10, 64
    s_load_dwordx16 s[84:99], s[38:39], s11 glc
    s_waitcnt lgkmcnt(0)
    s_mov_b32 s14, 0
    s_xor_b32 s11, s17, s101
    s_or_b32 s14, s14, s11
    s_xor_b32 s11, s85, s101
    s_or_b32 s14, s14, s11
    s_xor_b32 s11, s19, s101
    s_or_b32 s14, s14, s11
    s_xor_b32 s11, s87, s101
    s_or_b32 s14, s14, s11
    s_xor_b32 s11, s21, s101
    s_or_b32 s14, s14, s11
    s_xor_b32 s11, s89, s101
    s_or_b32 s14, s14, s11
    s_xor_b32 s11, s23, s101
    s_or_b32 s14, s14, s11
    s_xor_b32 s11, s91, s101
    s_or_b32 s14, s14, s11
    s_xor_b32 s11, s25, s101
    s_or_b32 s14, s14, s11
    s_xor_b32 s11, s93, s101
    s_or_b32 s14, s14, s11
    s_xor_b32 s11, s27, s101
    s_or_b32 s14, s14, s11
    s_xor_b32 s11, s95, s101
    s_or_b32 s14, s14, s11
    s_xor_b32 s11, s29, s101
    s_or_b32 s14, s14, s11
    s_xor_b32 s11, s97, s101
    s_or_b32 s14, s14, s11
    s_xor_b32 s11, s31, s101
    s_or_b32 s14, s14, s11
    s_xor_b32 s11, s99, s101
    s_or_b32 s14, s14, s11
    s_cmp_eq_u32 s14, 0
    s_cbranch_scc1 L_qd0
    s_sleep 1
    s_add_u32 s15, s15, 1
    s_cmp_lt_u32 s15, 200000
    s_cbranch_scc1 L_qc0
L_qd0:
    s_mov_b32 exec_lo, 65537
    s_mov_b32 exec_hi, 65537
    v_mov_b32 v16, s16
    v_mov_b32 v17, s18
    v_mov_b32 v18, s20
    v_mov_b32 v19, s22
    s_mov_b32 exec_lo, 131074
    s_mov_b32 exec_hi, 131074
    v_mov_b32 v16, s24
    v_mov_b32 v17, s26
    v_mov_b32 v18, s28
    v_mov_b32 v19, s30
    s_mov_b32 exec_lo, 262148
    s_mov_b32 exec_hi, 262148
    v_mov_b32 v16, s84
    v_mov_b32 v17, s86
    v_mov_b32 v18, s88
    v_mov_b32 v19, s90
    s_mov_b32 exec_lo, 524296
    s_mov_b32 exec_hi, 524296
    v_mov_b32 v16, s92
    v_mov_b32 v17, s94
    v_mov_b32 v18, s96
    v_mov_b32 v19, s98
    s_mov_b64 exec, -1
    s_add_u32 s10, s10, 128
    s_mov_b32 s15, 0
L_qc1:
    s_load_dwordx16 s[16:31], s[38:39], s10 glc
    s_add_u32 s11, s10, 64
    s_load_dwordx16 s[84:99], s[38:39], s11 glc
    s_waitcnt lgkmcnt(0)
    s_mov_b32 s14, 0
    s_xor_b32 s11, s17, s101
    s_or_b32 s14, s14, s11
    s_xor_b32 s11, s85, s101
    s_or_b32 s14, s14, s11
    s_xor_b32 s11, s19, s101
    s_or_b32 s14, s14, s11
    s_xor_b32 s11, s87, s101
    s_or_b32 s14, s14, s11
    s_xor_b32 s11, s21, s101
    s_or_b32 s14, s14, s11
    s_xor_b32 s11, s89, s101
    s_or_b32 s14, s14, s11
    s_xor_b32 s11, s23, s101
    s_or_b32 s14, s14, s11
    s_xor_b32 s11, s91, s101
    s_or_b32 s14, s14, s11
    s_xor_b32 s11, s25, s101
    s_or_b32 s14, s14, s11
    s_xor_b32 s11, s93, s101
    s_or_b32 s14, s14, s11
    s_xor_b32 s11, s27, s101
    s_or_b32 s14, s14, s11
    s_xor_b32 s11, s95, s101
    s_or_b32 s14, s14, s11
    s_xor_b32 s11, s29, s101
    s_or_b32 s14, s14, s11
    s_xor_b32 s11, s97, s101
    s_or_b32 s14, s14, s11
    s_xor_b32 s11, s31, s101
    s_or_b32 s14, s14, s11
    s_xor_b32 s11, s99, s101
    s_or_b32 s14, s14, s11
    s_cmp_eq_u32 s14, 0
    s_cbranch_scc1 L_qd1
    s_sleep 1
    s_add_u32 s15, s15, 1
    s_cmp_lt_u32 s15, 200000
    s_cbranch_scc1 L_qc1
L_qd1:
    s_mov_b32 exec_lo, 1048592
    s_mov_b32 exec_hi, 1048592
    v_mov_b32 v16, s16
    v_mov_b32 v17, s18
    v_mov_b32 v18, s20
    v_mov_b32 v19, s22
    s_mov_b32 exec_lo, 2097184
    s_mov_b32 exec_hi, 2097184
    v_mov_b32 v16, s24
    v_mov_b32 v17, s26
    v_mov_b32 v18, s28
    v_mov_b32 v19, s30
    s_mov_b32 exec_lo, 4194368
    s_mov_b32 exec_hi, 4194368
    v_mov_b32 v16, s84
    v_mov_b32 v17, s86
    v_mov_b32 v18, s88
    v_mov_b32 v19, s90
    s_mov_b32 exec_lo, 8388736
    s_mov_b32 exec_hi, 8388736
    v_mov_b32 v16, s92
    v_mov_b32 v17, s94
    v_mov_b32 v18, s96
    v_mov_b32 v19, s98
    s_mov_b64 exec, -1
    s_add_u32 s10, s10, 128
    s_mov_b32 s15, 0
L_qc2:
    s_load_dwordx16 s[16:31], s[38:39], s10 glc
    s_add_u32 s11, s10, 64
    s_load_dwordx16 s[84:99], s[38:39], s11 glc
    s_waitcnt lgkmcnt(0)
    s_mov_b32 s14, 0
    s_xor_b32 s11, s17, s101
    s_or_b32 s14, s14, s11
    s_xor_b32 s11, s85, s101
    s_or_b32 s14, s14, s11
    s_xor_b32 s11, s19, s101
    s_or_b32 s14, s14, s11
    s_xor_b32 s11, s87, s101
    s_or_b32 s14, s14, s11
    s_xor_b32 s11, s21, s101
    s_or_b32 s14, s14, s11
    s_xor_b32 s11, s89, s101
    s_or_b32 s14, s14, s11
    s_xor_b32 s11, s23, s101
    s_or_b32 s14, s14, s11
    s_xor_b32 s11, s91, s101
    s_or_b32 s14, s14, s11
    s_xor_b32 s11, s25, s101
    s_or_b32 s14, s14, s11
    s_xor_b32 s11, s93, s101
    s_or_b32 s14, s14, s11
    s_xor_b32 s11, s27, s101
    s_or_b32 s14, s14, s11
    s_xor_b32 s11, s95, s101
    s_or_b32 s14, s14, s11
    s_xor_b32 s11, s29, s101
    s_or_b32 s14, s14, s11
    s_xor_b32 s11, s97, s101
    s_or_b32 s14, s14, s11
    s_xor_b32 s11, s31, s101
    s_or_b32 s14, s14, s11
    s_xor_b32 s11, s99, s101
    s_or_b32 s14, s14, s11
    s_cmp_eq_u32 s14, 0
    s_cbranch_scc1 L_qd2
    s_sleep 1
    s_add_u32 s15, s15, 1
    s_cmp_lt_u32 s15, 200000
    s_cbranch_scc1 L_qc2
L_qd2:
    s_mov_b32 exec_lo, 16777472
    s_mov_b32 exec_hi, 16777472
    v_mov_b32 v16, s16
    v_mov_b32 v17, s18
    v_mov_b32 v18, s20
    v_mov_b32 v19, s22
    s_mov_b32 exec_lo, 33554944
    s_mov_b32 exec_hi, 33554944
    v_mov_b32 v16, s24
    v_mov_b32 v17, s26
    v_mov_b32 v18, s28
    v_mov_b32 v19, s30
    s_mov_b32 exec_lo, 67109888
    s_mov_b32 exec_hi, 67109888
    v_mov_b32 v16, s84
    v_mov_b32 v17, s86
    v_mov_b32 v18, s88
    v_mov_b32 v19, s90
    s_mov_b32 exec_lo, 134219776
    s_mov_b32 exec_hi, 134219776
    v_mov_b32 v16, s92
    v_mov_b32 v17, s94
    v_mov_b32 v18, s96
    v_mov_b32 v19, s98
    s_mov_b64 exec, -1
    s_add_u32 s10, s10, 128
    s_mov_b32 s15, 0
L_qc3:
    s_load_dwordx16 s[16:31], s[38:39], s10 glc
    s_add_u32 s11, s10, 64
    s_load_dwordx16 s[84:99], s[38:39], s11 glc
    s_waitcnt lgkmcnt(0)
    s_mov_b32 s14, 0
    s_xor_b32 s11, s17, s101
    s_or_b32 s14, s14, s11
    s_xor_b32 s11, s85, s101
    s_or_b32 s14, s14, s11
    s_xor_b32 s11, s19, s101
    s_or_b32 s14, s14, s11
    s_xor_b32 s11, s87, s101
    s_or_b32 s14, s14, s11
    s_xor_b32 s11, s21, s101
    s_or_b32 s14, s14, s11
    s_xor_b32 s11, s89, s101
    s_or_b32 s14, s14, s11
    s_xor_b32 s11, s23, s101
    s_or_b32 s14, s14, s11
    s_xor_b32 s11, s91, s101
    s_or_b32 s14, s14, s11
    s_xor_b32 s11, s25, s101
    s_or_b32 s14, s14, s11
    s_xor_b32 s11, s93, s101
    s_or_b32 s14, s14, s11
    s_xor_b32 s11, s27, s101
    s_or_b32 s14, s14, s11
    s_xor_b32 s11, s95, s101
    s_or_b32 s14, s14, s11
    s_xor_b32 s11, s29, s101
    s_or_b32 s14, s14, s11
    s_xor_b32 s11, s97, s101
    s_or_b32 s14, s14, s11
    s_xor_b32 s11, s31, s101
    s_or_b32 s14, s14, s11
    s_xor_b32 s11, s99, s101
    s_or_b32 s14, s14, s11
    s_cmp_eq_u32 s14, 0
    s_cbranch_scc1 L_qd3
    s_sleep 1
    s_add_u32 s15, s15, 1
    s_cmp_lt_u32 s15, 200000
    s_cbranch_scc1 L_qc3
L_qd3:
    s_mov_b32 exec_lo, 268439552
    s_mov_b32 exec_hi, 268439552
    v_mov_b32 v16, s16
    v_mov_b32 v17, s18
    v_mov_b32 v18, s20
    v_mov_b32 v19, s22
    s_mov_b32 exec_lo, 536879104
    s_mov_b32 exec_hi, 536879104
    v_mov_b32 v16, s24
    v_mov_b32 v17, s26
    v_mov_b32 v18, s28
    v_mov_b32 v19, s30
    s_mov_b32 exec_lo, 1073758208
    s_mov_b32 exec_hi, 1073758208
    v_mov_b32 v16, s84
    v_mov_b32 v17, s86
    v_mov_b32 v18, s88
    v_mov_b32 v19, s90
    s_mov_b32 exec_lo, 2147516416
    s_mov_b32 exec_hi, 2147516416
    v_mov_b32 v16, s92
    v_mov_b32 v17, s94
    v_mov_b32 v18, s96
    v_mov_b32 v19, s98
    s_mov_b64 exec, -1
    s_add_u32 s10, s10, 128
    ds_write_b128 v2, v[16:19]
    s_waitcnt lgkmcnt(0)
L_qwait:
    s_barrier
    ds_read_b128 v[16:19], v2
    s_waitcnt lgkmcnt(0)
    s_mov_b32 s10, s9
    s_waitcnt vmcnt(28)
    v_dot2_f32_bf16 v32, v112, v16, 0
    v_dot2_f32_bf16 v33, v116, v16, 0
    v_dot2_f32_bf16 v34, v120, v16, 0
    v_dot2_f32_bf16 v35, v124, v16, 0
    v_dot2_f32_bf16 v32, v113, v17, v32
    v_dot2_f32_bf16 v33, v117, v17, v33
    v_dot2_f32_bf16 v34, v121, v17, v34
    v_dot2_f32_bf16 v35, v125, v17, v35
    v_dot2_f32_bf16 v32, v114, v18, v32
    v_dot2_f32_bf16 v33, v118, v18, v33
    v_dot2_f32_bf16 v34, v122, v18, v34
    v_dot2_f32_bf16 v35, v126, v18, v35
    v_dot2_f32_bf16 v32, v115, v19, v32
    v_dot2_f32_bf16 v33, v119, v19, v33
    v_dot2_f32_bf16 v34, v123, v19, v34
    v_dot2_f32_bf16 v35, v127, v19, v35
    s_add_u32 s10, s83, 0
    s_and_b32 s10, s10, 0x7fff
    s_add_u32 s10, s10, s9
    buffer_load_dwordx4 v[112:115], v4, s[44:47], s10 offen nt
    s_add_u32 s10, s83, 1024
    s_and_b32 s10, s10, 0x7fff
    s_add_u32 s10, s10, s9
    buffer_load_dwordx4 v[116:119], v4, s[44:47], s10 offen nt
    s_add_u32 s10, s83, 2048
    s_and_b32 s10, s10, 0x7fff
    s_add_u32 s10, s10, s9
    buffer_load_dwordx4 v[120:123], v4, s[44:47], s10 offen nt
    s_add_u32 s10, s83, 3072
    s_and_b32 s10, s10, 0x7fff
    s_add_u32 s10, s10, s9
    buffer_load_dwordx4 v[124:127], v4, s[44:47], s10 offen nt
    v_add_f32_dpp v32, v32, v32 row_ror:8 row_mask:0xf bank_mask:0xf
    v_add_f32_dpp v33, v33, v33 row_ror:8 row_mask:0xf bank_mask:0xf
    v_add_f32_dpp v34, v34, v34 row_ror:8 row_mask:0xf bank_mask:0xf
    v_add_f32_dpp v35, v35, v35 row_ror:8 row_mask:0xf bank_mask:0xf
    v_add_f32_dpp v32, v32, v32 row_ror:4 row_mask:0xf bank_mask:0xf
    v_add_f32_dpp v33, v33, v33 row_ror:4 row_mask:0xf bank_mask:0xf
    v_add_f32_dpp v34, v34, v34 row_ror:4 row_mask:0xf bank_mask:0xf
    v_add_f32_dpp v35, v35, v35 row_ror:4 row_mask:0xf bank_mask:0xf
    v_add_f32_dpp v32, v32, v32 row_ror:2 row_mask:0xf bank_mask:0xf
    v_add_f32_dpp v33, v33, v33 row_ror:2 row_mask:0xf bank_mask:0xf
    v_add_f32_dpp v34, v34, v34 row_ror:2 row_mask:0xf bank_mask:0xf
    v_add_f32_dpp v35, v35, v35 row_ror:2 row_mask:0xf bank_mask:0xf
    v_add_f32_dpp v32, v32, v32 row_ror:1 row_mask:0xf bank_mask:0xf
    v_add_f32_dpp v33, v33, v33 row_ror:1 row_mask:0xf bank_mask:0xf
    v_add_f32_dpp v34, v34, v34 row_ror:1 row_mask:0xf bank_mask:0xf
    v_add_f32_dpp v35, v35, v35 row_ror:1 row_mask:0xf bank_mask:0xf
    v_cvt_pk_bf16_f32 v20, v32, v32
    v_cvt_pk_bf16_f32 v21, v33, v33
    v_cvt_pk_bf16_f32 v22, v34, v34
    v_cvt_pk_bf16_f32 v23, v35, v35
    v_lshlrev_b32 v32, 16, v20
    v_lshlrev_b32 v33, 16, v21
    v_lshlrev_b32 v34, 16, v22
    v_lshlrev_b32 v35, 16, v23
    v_mul_f32 v32, s12, v32
    v_mul_f32 v33, s12, v33
    v_mul_f32 v34, s12, v34
    v_mul_f32 v35, s12, v35
    v_cvt_pk_bf16_f32 v20, v32, v32
    v_cvt_pk_bf16_f32 v21, v33, v33
    v_cvt_pk_bf16_f32 v22, v34, v34
    v_cvt_pk_bf16_f32 v23, v35, v35
    v_lshlrev_b32 v32, 16, v20
    v_lshlrev_b32 v33, 16, v21
    v_lshlrev_b32 v34, 16, v22
    v_lshlrev_b32 v35, 16, v23
    s_waitcnt vmcnt(28)
    v_dot2_f32_bf16 v36, v128, v16, 0
    v_dot2_f32_bf16 v37, v132, v16, 0
    v_dot2_f32_bf16 v38, v136, v16, 0
    v_dot2_f32_bf16 v39, v140, v16, 0
    v_dot2_f32_bf16 v36, v129, v17, v36
    v_dot2_f32_bf16 v37, v133, v17, v37
    v_dot2_f32_bf16 v38, v137, v17, v38
    v_dot2_f32_bf16 v39, v141, v17, v39
    v_dot2_f32_bf16 v36, v130, v18, v36
    v_dot2_f32_bf16 v37, v134, v18, v37
    v_dot2_f32_bf16 v38, v138, v18, v38
    v_dot2_f32_bf16 v39, v142, v18, v39
    v_dot2_f32_bf16 v36, v131, v19, v36
    v_dot2_f32_bf16 v37, v135, v19, v37
    v_dot2_f32_bf16 v38, v139, v19, v38
    v_dot2_f32_bf16 v39, v143, v19, v39
    s_add_u32 s10, s83, 4096
    s_and_b32 s10, s10, 0x7fff
    s_add_u32 s10, s10, s9
    buffer_load_dwordx4 v[128:131], v4, s[44:47], s10 offen nt
    s_add_u32 s10, s83, 5120
    s_and_b32 s10, s10, 0x7fff
    s_add_u32 s10, s10, s9
    buffer_load_dwordx4 v[132:135], v4, s[44:47], s10 offen nt
    s_add_u32 s10, s83, 6144
    s_and_b32 s10, s10, 0x7fff
    s_add_u32 s10, s10, s9
    buffer_load_dwordx4 v[136:139], v4, s[44:47], s10 offen nt
    s_add_u32 s10, s83, 7168
    s_and_b32 s10, s10, 0x7fff
    s_add_u32 s10, s10, s9
    buffer_load_dwordx4 v[140:143], v4, s[44:47], s10 offen nt
    v_add_f32_dpp v36, v36, v36 row_ror:8 row_mask:0xf bank_mask:0xf
    v_add_f32_dpp v37, v37, v37 row_ror:8 row_mask:0xf bank_mask:0xf
    v_add_f32_dpp v38, v38, v38 row_ror:8 row_mask:0xf bank_mask:0xf
    v_add_f32_dpp v39, v39, v39 row_ror:8 row_mask:0xf bank_mask:0xf
    v_add_f32_dpp v36, v36, v36 row_ror:4 row_mask:0xf bank_mask:0xf
    v_add_f32_dpp v37, v37, v37 row_ror:4 row_mask:0xf bank_mask:0xf
    v_add_f32_dpp v38, v38, v38 row_ror:4 row_mask:0xf bank_mask:0xf
    v_add_f32_dpp v39, v39, v39 row_ror:4 row_mask:0xf bank_mask:0xf
    v_add_f32_dpp v36, v36, v36 row_ror:2 row_mask:0xf bank_mask:0xf
    v_add_f32_dpp v37, v37, v37 row_ror:2 row_mask:0xf bank_mask:0xf
    v_add_f32_dpp v38, v38, v38 row_ror:2 row_mask:0xf bank_mask:0xf
    v_add_f32_dpp v39, v39, v39 row_ror:2 row_mask:0xf bank_mask:0xf
    v_add_f32_dpp v36, v36, v36 row_ror:1 row_mask:0xf bank_mask:0xf
    v_add_f32_dpp v37, v37, v37 row_ror:1 row_mask:0xf bank_mask:0xf
    v_add_f32_dpp v38, v38, v38 row_ror:1 row_mask:0xf bank_mask:0xf
    v_add_f32_dpp v39, v39, v39 row_ror:1 row_mask:0xf bank_mask:0xf
    v_cvt_pk_bf16_f32 v20, v36, v36
    v_cvt_pk_bf16_f32 v21, v37, v37
    v_cvt_pk_bf16_f32 v22, v38, v38
    v_cvt_pk_bf16_f32 v23, v39, v39
    v_lshlrev_b32 v36, 16, v20
    v_lshlrev_b32 v37, 16, v21
    v_lshlrev_b32 v38, 16, v22
    v_lshlrev_b32 v39, 16, v23
    v_mul_f32 v36, s12, v36
    v_mul_f32 v37, s12, v37
    v_mul_f32 v38, s12, v38
    v_mul_f32 v39, s12, v39
    v_cvt_pk_bf16_f32 v20, v36, v36
    v_cvt_pk_bf16_f32 v21, v37, v37
    v_cvt_pk_bf16_f32 v22, v38, v38
    v_cvt_pk_bf16_f32 v23, v39, v39
    v_lshlrev_b32 v36, 16, v20
    v_lshlrev_b32 v37, 16, v21
    v_lshlrev_b32 v38, 16, v22
    v_lshlrev_b32 v39, 16, v23
    s_waitcnt vmcnt(28)
    v_dot2_f32_bf16 v40, v144, v16, 0
    v_dot2_f32_bf16 v41, v148, v16, 0
    v_dot2_f32_bf16 v42, v152, v16, 0
    v_dot2_f32_bf16 v43, v156, v16, 0
    v_dot2_f32_bf16 v40, v145, v17, v40
    v_dot2_f32_bf16 v41, v149, v17, v41
    v_dot2_f32_bf16 v42, v153, v17, v42
    v_dot2_f32_bf16 v43, v157, v17, v43
    v_dot2_f32_bf16 v40, v146, v18, v40
    v_dot2_f32_bf16 v41, v150, v18, v41
    v_dot2_f32_bf16 v42, v154, v18, v42
    v_dot2_f32_bf16 v43, v158, v18, v43
    v_dot2_f32_bf16 v40, v147, v19, v40
    v_dot2_f32_bf16 v41, v151, v19, v41
    v_dot2_f32_bf16 v42, v155, v19, v42
    v_dot2_f32_bf16 v43, v159, v19, v43
    s_add_u32 s10, s83, 8192
    s_and_b32 s10, s10, 0x7fff
    s_add_u32 s10, s10, s9
    buffer_load_dwordx4 v[144:147], v4, s[44:47], s10 offen nt
    s_add_u32 s10, s83, 9216
    s_and_b32 s10, s10, 0x7fff
    s_add_u32 s10, s10, s9
    buffer_load_dwordx4 v[148:151], v4, s[44:47], s10 offen nt
    s_add_u32 s10, s83, 10240
    s_and_b32 s10, s10, 0x7fff
    s_add_u32 s10, s10, s9
    buffer_load_dwordx4 v[152:155], v4, s[44:47], s10 offen nt
    s_add_u32 s10, s83, 11264
    s_and_b32 s10, s10, 0x7fff
    s_add_u32 s10, s10, s9
    buffer_load_dwordx4 v[156:159], v4, s[44:47], s10 offen nt
    v_add_f32_dpp v40, v40, v40 row_ror:8 row_mask:0xf bank_mask:0xf
    v_add_f32_dpp v41, v41, v41 row_ror:8 row_mask:0xf bank_mask:0xf
    v_add_f32_dpp v42, v42, v42 row_ror:8 row_mask:0xf bank_mask:0xf
    v_add_f32_dpp v43, v43, v43 row_ror:8 row_mask:0xf bank_mask:0xf
    v_add_f32_dpp v40, v40, v40 row_ror:4 row_mask:0xf bank_mask:0xf
    v_add_f32_dpp v41, v41, v41 row_ror:4 row_mask:0xf bank_mask:0xf
    v_add_f32_dpp v42, v42, v42 row_ror:4 row_mask:0xf bank_mask:0xf
    v_add_f32_dpp v43, v43, v43 row_ror:4 row_mask:0xf bank_mask:0xf
    v_add_f32_dpp v40, v40, v40 row_ror:2 row_mask:0xf bank_mask:0xf
    v_add_f32_dpp v41, v41, v41 row_ror:2 row_mask:0xf bank_mask:0xf
    v_add_f32_dpp v42, v42, v42 row_ror:2 row_mask:0xf bank_mask:0xf
    v_add_f32_dpp v43, v43, v43 row_ror:2 row_mask:0xf bank_mask:0xf
    v_add_f32_dpp v40, v40, v40 row_ror:1 row_mask:0xf bank_mask:0xf
    v_add_f32_dpp v41, v41, v41 row_ror:1 row_mask:0xf bank_mask:0xf
    v_add_f32_dpp v42, v42, v42 row_ror:1 row_mask:0xf bank_mask:0xf
    v_add_f32_dpp v43, v43, v43 row_ror:1 row_mask:0xf bank_mask:0xf
    v_cvt_pk_bf16_f32 v20, v40, v40
    v_cvt_pk_bf16_f32 v21, v41, v41
    v_cvt_pk_bf16_f32 v22, v42, v42
    v_cvt_pk_bf16_f32 v23, v43, v43
    v_lshlrev_b32 v40, 16, v20
    v_lshlrev_b32 v41, 16, v21
    v_lshlrev_b32 v42, 16, v22
    v_lshlrev_b32 v43, 16, v23
    v_mul_f32 v40, s12, v40
    v_mul_f32 v41, s12, v41
    v_mul_f32 v42, s12, v42
    v_mul_f32 v43, s12, v43
    v_cvt_pk_bf16_f32 v20, v40, v40
    v_cvt_pk_bf16_f32 v21, v41, v41
    v_cvt_pk_bf16_f32 v22, v42, v42
    v_cvt_pk_bf16_f32 v23, v43, v43
    v_lshlrev_b32 v40, 16, v20
    v_lshlrev_b32 v41, 16, v21
    v_lshlrev_b32 v42, 16, v22
    v_lshlrev_b32 v43, 16, v23
    s_waitcnt vmcnt(28)
    v_dot2_f32_bf16 v44, v160, v16, 0
    v_dot2_f32_bf16 v45, v164, v16, 0
    v_dot2_f32_bf16 v46, v168, v16, 0
    v_dot2_f32_bf16 v47, v172, v16, 0
    v_dot2_f32_bf16 v44, v161, v17, v44
    v_dot2_f32_bf16 v45, v165, v17, v45
    v_dot2_f32_bf16 v46, v169, v17, v46
    v_dot2_f32_bf16 v47, v173, v17, v47
    v_dot2_f32_bf16 v44, v162, v18, v44
    v_dot2_f32_bf16 v45, v166, v18, v45
    v_dot2_f32_bf16 v46, v170, v18, v46
    v_dot2_f32_bf16 v47, v174, v18, v47
    v_dot2_f32_bf16 v44, v163, v19, v44
    v_dot2_f32_bf16 v45, v167, v19, v45
    v_dot2_f32_bf16 v46, v171, v19, v46
    v_dot2_f32_bf16 v47, v175, v19, v47
    s_add_u32 s10, s83, 12288
    s_and_b32 s10, s10, 0x7fff
    s_add_u32 s10, s10, s9
    buffer_load_dwordx4 v[160:163], v4, s[44:47], s10 offen nt
    s_add_u32 s10, s83, 13312
    s_and_b32 s10, s10, 0x7fff
    s_add_u32 s10, s10, s9
    buffer_load_dwordx4 v[164:167], v4, s[44:47], s10 offen nt
    s_add_u32 s10, s83, 14336
    s_and_b32 s10, s10, 0x7fff
    s_add_u32 s10, s10, s9
    buffer_load_dwordx4 v[168:171], v4, s[44:47], s10 offen nt
    s_add_u32 s10, s83, 15360
    s_and_b32 s10, s10, 0x7fff
    s_add_u32 s10, s10, s9
    buffer_load_dwordx4 v[172:175], v4, s[44:47], s10 offen nt
    v_add_f32_dpp v44, v44, v44 row_ror:8 row_mask:0xf bank_mask:0xf
    v_add_f32_dpp v45, v45, v45 row_ror:8 row_mask:0xf bank_mask:0xf
    v_add_f32_dpp v46, v46, v46 row_ror:8 row_mask:0xf bank_mask:0xf
    v_add_f32_dpp v47, v47, v47 row_ror:8 row_mask:0xf bank_mask:0xf
    v_add_f32_dpp v44, v44, v44 row_ror:4 row_mask:0xf bank_mask:0xf
    v_add_f32_dpp v45, v45, v45 row_ror:4 row_mask:0xf bank_mask:0xf
    v_add_f32_dpp v46, v46, v46 row_ror:4 row_mask:0xf bank_mask:0xf
    v_add_f32_dpp v47, v47, v47 row_ror:4 row_mask:0xf bank_mask:0xf
    v_add_f32_dpp v44, v44, v44 row_ror:2 row_mask:0xf bank_mask:0xf
    v_add_f32_dpp v45, v45, v45 row_ror:2 row_mask:0xf bank_mask:0xf
    v_add_f32_dpp v46, v46, v46 row_ror:2 row_mask:0xf bank_mask:0xf
    v_add_f32_dpp v47, v47, v47 row_ror:2 row_mask:0xf bank_mask:0xf
    v_add_f32_dpp v44, v44, v44 row_ror:1 row_mask:0xf bank_mask:0xf
    v_add_f32_dpp v45, v45, v45 row_ror:1 row_mask:0xf bank_mask:0xf
    v_add_f32_dpp v46, v46, v46 row_ror:1 row_mask:0xf bank_mask:0xf
    v_add_f32_dpp v47, v47, v47 row_ror:1 row_mask:0xf bank_mask:0xf
    v_cvt_pk_bf16_f32 v20, v44, v44
    v_cvt_pk_bf16_f32 v21, v45, v45
    v_cvt_pk_bf16_f32 v22, v46, v46
    v_cvt_pk_bf16_f32 v23, v47, v47
    v_lshlrev_b32 v44, 16, v20
    v_lshlrev_b32 v45, 16, v21
    v_lshlrev_b32 v46, 16, v22
    v_lshlrev_b32 v47, 16, v23
    v_mul_f32 v44, s12, v44
    v_mul_f32 v45, s12, v45
    v_mul_f32 v46, s12, v46
    v_mul_f32 v47, s12, v47
    v_cvt_pk_bf16_f32 v20, v44, v44
    v_cvt_pk_bf16_f32 v21, v45, v45
    v_cvt_pk_bf16_f32 v22, v46, v46
    v_cvt_pk_bf16_f32 v23, v47, v47
    v_lshlrev_b32 v44, 16, v20
    v_lshlrev_b32 v45, 16, v21
    v_lshlrev_b32 v46, 16, v22
    v_lshlrev_b32 v47, 16, v23
    s_waitcnt vmcnt(28)
    v_dot2_f32_bf16 v48, v176, v16, 0
    v_dot2_f32_bf16 v49, v180, v16, 0
    v_dot2_f32_bf16 v50, v184, v16, 0
    v_dot2_f32_bf16 v51, v188, v16, 0
    v_dot2_f32_bf16 v48, v177, v17, v48
    v_dot2_f32_bf16 v49, v181, v17, v49
    v_dot2_f32_bf16 v50, v185, v17, v50
    v_dot2_f32_bf16 v51, v189, v17, v51
    v_dot2_f32_bf16 v48, v178, v18, v48
    v_dot2_f32_bf16 v49, v182, v18, v49
    v_dot2_f32_bf16 v50, v186, v18, v50
    v_dot2_f32_bf16 v51, v190, v18, v51
    v_dot2_f32_bf16 v48, v179, v19, v48
    v_dot2_f32_bf16 v49, v183, v19, v49
    v_dot2_f32_bf16 v50, v187, v19, v50
    v_dot2_f32_bf16 v51, v191, v19, v51
    s_add_u32 s10, s83, 16384
    s_and_b32 s10, s10, 0x7fff
    s_add_u32 s10, s10, s9
    buffer_load_dwordx4 v[176:179], v4, s[44:47], s10 offen nt
    s_add_u32 s10, s83, 17408
    s_and_b32 s10, s10, 0x7fff
    s_add_u32 s10, s10, s9
    buffer_load_dwordx4 v[180:183], v4, s[44:47], s10 offen nt
    s_add_u32 s10, s83, 18432
    s_and_b32 s10, s10, 0x7fff
    s_add_u32 s10, s10, s9
    buffer_load_dwordx4 v[184:187], v4, s[44:47], s10 offen nt
    s_add_u32 s10, s83, 19456
    s_and_b32 s10, s10, 0x7fff
    s_add_u32 s10, s10, s9
    buffer_load_dwordx4 v[188:191], v4, s[44:47], s10 offen nt
    v_add_f32_dpp v48, v48, v48 row_ror:8 row_mask:0xf bank_mask:0xf
    v_add_f32_dpp v49, v49, v49 row_ror:8 row_mask:0xf bank_mask:0xf
    v_add_f32_dpp v50, v50, v50 row_ror:8 row_mask:0xf bank_mask:0xf
    v_add_f32_dpp v51, v51, v51 row_ror:8 row_mask:0xf bank_mask:0xf
    v_add_f32_dpp v48, v48, v48 row_ror:4 row_mask:0xf bank_mask:0xf
    v_add_f32_dpp v49, v49, v49 row_ror:4 row_mask:0xf bank_mask:0xf
    v_add_f32_dpp v50, v50, v50 row_ror:4 row_mask:0xf bank_mask:0xf
    v_add_f32_dpp v51, v51, v51 row_ror:4 row_mask:0xf bank_mask:0xf
    v_add_f32_dpp v48, v48, v48 row_ror:2 row_mask:0xf bank_mask:0xf
    v_add_f32_dpp v49, v49, v49 row_ror:2 row_mask:0xf bank_mask:0xf
    v_add_f32_dpp v50, v50, v50 row_ror:2 row_mask:0xf bank_mask:0xf
    v_add_f32_dpp v51, v51, v51 row_ror:2 row_mask:0xf bank_mask:0xf
    v_add_f32_dpp v48, v48, v48 row_ror:1 row_mask:0xf bank_mask:0xf
    v_add_f32_dpp v49, v49, v49 row_ror:1 row_mask:0xf bank_mask:0xf
    v_add_f32_dpp v50, v50, v50 row_ror:1 row_mask:0xf bank_mask:0xf
    v_add_f32_dpp v51, v51, v51 row_ror:1 row_mask:0xf bank_mask:0xf
    v_cvt_pk_bf16_f32 v20, v48, v48
    v_cvt_pk_bf16_f32 v21, v49, v49
    v_cvt_pk_bf16_f32 v22, v50, v50
    v_cvt_pk_bf16_f32 v23, v51, v51
    v_lshlrev_b32 v48, 16, v20
    v_lshlrev_b32 v49, 16, v21
    v_lshlrev_b32 v50, 16, v22
    v_lshlrev_b32 v51, 16, v23
    v_mul_f32 v48, s12, v48
    v_mul_f32 v49, s12, v49
    v_mul_f32 v50, s12, v50
    v_mul_f32 v51, s12, v51
    v_cvt_pk_bf16_f32 v20, v48, v48
    v_cvt_pk_bf16_f32 v21, v49, v49
    v_cvt_pk_bf16_f32 v22, v50, v50
    v_cvt_pk_bf16_f32 v23, v51, v51
    v_lshlrev_b32 v48, 16, v20
    v_lshlrev_b32 v49, 16, v21
    v_lshlrev_b32 v50, 16, v22
    v_lshlrev_b32 v51, 16, v23
    s_waitcnt vmcnt(28)
    v_dot2_f32_bf16 v52, v192, v16, 0
    v_dot2_f32_bf16 v53, v196, v16, 0
    v_dot2_f32_bf16 v54, v200, v16, 0
    v_dot2_f32_bf16 v55, v204, v16, 0
    v_dot2_f32_bf16 v52, v193, v17, v52
    v_dot2_f32_bf16 v53, v197, v17, v53
    v_dot2_f32_bf16 v54, v201, v17, v54
    v_dot2_f32_bf16 v55, v205, v17, v55
    v_dot2_f32_bf16 v52, v194, v18, v52
    v_dot2_f32_bf16 v53, v198, v18, v53
    v_dot2_f32_bf16 v54, v202, v18, v54
    v_dot2_f32_bf16 v55, v206, v18, v55
    v_dot2_f32_bf16 v52, v195, v19, v52
    v_dot2_f32_bf16 v53, v199, v19, v53
    v_dot2_f32_bf16 v54, v203, v19, v54
    v_dot2_f32_bf16 v55, v207, v19, v55
    s_add_u32 s10, s83, 20480
    s_and_b32 s10, s10, 0x7fff
    s_add_u32 s10, s10, s9
    buffer_load_dwordx4 v[192:195], v4, s[44:47], s10 offen nt
    s_add_u32 s10, s83, 21504
    s_and_b32 s10, s10, 0x7fff
    s_add_u32 s10, s10, s9
    buffer_load_dwordx4 v[196:199], v4, s[44:47], s10 offen nt
    s_add_u32 s10, s83, 22528
    s_and_b32 s10, s10, 0x7fff
    s_add_u32 s10, s10, s9
    buffer_load_dwordx4 v[200:203], v4, s[44:47], s10 offen nt
    s_add_u32 s10, s83, 23552
    s_and_b32 s10, s10, 0x7fff
    s_add_u32 s10, s10, s9
    buffer_load_dwordx4 v[204:207], v4, s[44:47], s10 offen nt
    v_add_f32_dpp v52, v52, v52 row_ror:8 row_mask:0xf bank_mask:0xf
    v_add_f32_dpp v53, v53, v53 row_ror:8 row_mask:0xf bank_mask:0xf
    v_add_f32_dpp v54, v54, v54 row_ror:8 row_mask:0xf bank_mask:0xf
    v_add_f32_dpp v55, v55, v55 row_ror:8 row_mask:0xf bank_mask:0xf
    v_add_f32_dpp v52, v52, v52 row_ror:4 row_mask:0xf bank_mask:0xf
    v_add_f32_dpp v53, v53, v53 row_ror:4 row_mask:0xf bank_mask:0xf
    v_add_f32_dpp v54, v54, v54 row_ror:4 row_mask:0xf bank_mask:0xf
    v_add_f32_dpp v55, v55, v55 row_ror:4 row_mask:0xf bank_mask:0xf
    v_add_f32_dpp v52, v52, v52 row_ror:2 row_mask:0xf bank_mask:0xf
    v_add_f32_dpp v53, v53, v53 row_ror:2 row_mask:0xf bank_mask:0xf
    v_add_f32_dpp v54, v54, v54 row_ror:2 row_mask:0xf bank_mask:0xf
    v_add_f32_dpp v55, v55, v55 row_ror:2 row_mask:0xf bank_mask:0xf
    v_add_f32_dpp v52, v52, v52 row_ror:1 row_mask:0xf bank_mask:0xf
    v_add_f32_dpp v53, v53, v53 row_ror:1 row_mask:0xf bank_mask:0xf
    v_add_f32_dpp v54, v54, v54 row_ror:1 row_mask:0xf bank_mask:0xf
    v_add_f32_dpp v55, v55, v55 row_ror:1 row_mask:0xf bank_mask:0xf
    v_cvt_pk_bf16_f32 v20, v52, v52
    v_cvt_pk_bf16_f32 v21, v53, v53
    v_cvt_pk_bf16_f32 v22, v54, v54
    v_cvt_pk_bf16_f32 v23, v55, v55
    v_lshlrev_b32 v52, 16, v20
    v_lshlrev_b32 v53, 16, v21
    v_lshlrev_b32 v54, 16, v22
    v_lshlrev_b32 v55, 16, v23
    v_mul_f32 v52, s12, v52
    v_mul_f32 v53, s12, v53
    v_mul_f32 v54, s12, v54
    v_mul_f32 v55, s12, v55
    v_cvt_pk_bf16_f32 v20, v52, v52
    v_cvt_pk_bf16_f32 v21, v53, v53
    v_cvt_pk_bf16_f32 v22, v54, v54
    v_cvt_pk_bf16_f32 v23, v55, v55
    v_lshlrev_b32 v52, 16, v20
    v_lshlrev_b32 v53, 16, v21
    v_lshlrev_b32 v54, 16, v22
    v_lshlrev_b32 v55, 16, v23
    s_waitcnt vmcnt(28)
    v_dot2_f32_bf16 v56, v208, v16, 0
    v_dot2_f32_bf16 v57, v212, v16, 0
    v_dot2_f32_bf16 v58, v216, v16, 0
    v_dot2_f32_bf16 v59, v220, v16, 0
    v_dot2_f32_bf16 v56, v209, v17, v56
    v_dot2_f32_bf16 v57, v213, v17, v57
    v_dot2_f32_bf16 v58, v217, v17, v58
    v_dot2_f32_bf16 v59, v221, v17, v59
    v_dot2_f32_bf16 v56, v210, v18, v56
    v_dot2_f32_bf16 v57, v214, v18, v57
    v_dot2_f32_bf16 v58, v218, v18, v58
    v_dot2_f32_bf16 v59, v222, v18, v59
    v_dot2_f32_bf16 v56, v211, v19, v56
    v_dot2_f32_bf16 v57, v215, v19, v57
    v_dot2_f32_bf16 v58, v219, v19, v58
    v_dot2_f32_bf16 v59, v223, v19, v59
    s_add_u32 s10, s83, 24576
    s_and_b32 s10, s10, 0x7fff
    s_add_u32 s10, s10, s9
    buffer_load_dwordx4 v[208:211], v4, s[44:47], s10 offen nt
    s_add_u32 s10, s83, 25600
    s_and_b32 s10, s10, 0x7fff
    s_add_u32 s10, s10, s9
    buffer_load_dwordx4 v[212:215], v4, s[44:47], s10 offen nt
    s_add_u32 s10, s83, 26624
    s_and_b32 s10, s10, 0x7fff
    s_add_u32 s10, s10, s9
    buffer_load_dwordx4 v[216:219], v4, s[44:47], s10 offen nt
    s_add_u32 s10, s83, 27648
    s_and_b32 s10, s10, 0x7fff
    s_add_u32 s10, s10, s9
    buffer_load_dwordx4 v[220:223], v4, s[44:47], s10 offen nt
    v_add_f32_dpp v56, v56, v56 row_ror:8 row_mask:0xf bank_mask:0xf
    v_add_f32_dpp v57, v57, v57 row_ror:8 row_mask:0xf bank_mask:0xf
    v_add_f32_dpp v58, v58, v58 row_ror:8 row_mask:0xf bank_mask:0xf
    v_add_f32_dpp v59, v59, v59 row_ror:8 row_mask:0xf bank_mask:0xf
    v_add_f32_dpp v56, v56, v56 row_ror:4 row_mask:0xf bank_mask:0xf
    v_add_f32_dpp v57, v57, v57 row_ror:4 row_mask:0xf bank_mask:0xf
    v_add_f32_dpp v58, v58, v58 row_ror:4 row_mask:0xf bank_mask:0xf
    v_add_f32_dpp v59, v59, v59 row_ror:4 row_mask:0xf bank_mask:0xf
    v_add_f32_dpp v56, v56, v56 row_ror:2 row_mask:0xf bank_mask:0xf
    v_add_f32_dpp v57, v57, v57 row_ror:2 row_mask:0xf bank_mask:0xf
    v_add_f32_dpp v58, v58, v58 row_ror:2 row_mask:0xf bank_mask:0xf
    v_add_f32_dpp v59, v59, v59 row_ror:2 row_mask:0xf bank_mask:0xf
    v_add_f32_dpp v56, v56, v56 row_ror:1 row_mask:0xf bank_mask:0xf
    v_add_f32_dpp v57, v57, v57 row_ror:1 row_mask:0xf bank_mask:0xf
    v_add_f32_dpp v58, v58, v58 row_ror:1 row_mask:0xf bank_mask:0xf
    v_add_f32_dpp v59, v59, v59 row_ror:1 row_mask:0xf bank_mask:0xf
    v_cvt_pk_bf16_f32 v20, v56, v56
    v_cvt_pk_bf16_f32 v21, v57, v57
    v_cvt_pk_bf16_f32 v22, v58, v58
    v_cvt_pk_bf16_f32 v23, v59, v59
    v_lshlrev_b32 v56, 16, v20
    v_lshlrev_b32 v57, 16, v21
    v_lshlrev_b32 v58, 16, v22
    v_lshlrev_b32 v59, 16, v23
    v_mul_f32 v56, s12, v56
    v_mul_f32 v57, s12, v57
    v_mul_f32 v58, s12, v58
    v_mul_f32 v59, s12, v59
    v_cvt_pk_bf16_f32 v20, v56, v56
    v_cvt_pk_bf16_f32 v21, v57, v57
    v_cvt_pk_bf16_f32 v22, v58, v58
    v_cvt_pk_bf16_f32 v23, v59, v59
    v_lshlrev_b32 v56, 16, v20
    v_lshlrev_b32 v57, 16, v21
    v_lshlrev_b32 v58, 16, v22
    v_lshlrev_b32 v59, 16, v23
    s_waitcnt vmcnt(28)
    v_dot2_f32_bf16 v60, v224, v16, 0
    v_dot2_f32_bf16 v61, v228, v16, 0
    v_dot2_f32_bf16 v62, v232, v16, 0
    v_dot2_f32_bf16 v63, v236, v16, 0
    v_dot2_f32_bf16 v60, v225, v17, v60
    v_dot2_f32_bf16 v61, v229, v17, v61
    v_dot2_f32_bf16 v62, v233, v17, v62
    v_dot2_f32_bf16 v63, v237, v17, v63
    v_dot2_f32_bf16 v60, v226, v18, v60
    v_dot2_f32_bf16 v61, v230, v18, v61
    v_dot2_f32_bf16 v62, v234, v18, v62
    v_dot2_f32_bf16 v63, v238, v18, v63
    v_dot2_f32_bf16 v60, v227, v19, v60
    v_dot2_f32_bf16 v61, v231, v19, v61
    v_dot2_f32_bf16 v62, v235, v19, v62
    v_dot2_f32_bf16 v63, v239, v19, v63
    s_add_u32 s10, s83, 28672
    s_and_b32 s10, s10, 0x7fff
    s_add_u32 s10, s10, s9
    buffer_load_dwordx4 v[224:227], v4, s[44:47], s10 offen nt
    s_add_u32 s10, s83, 29696
    s_and_b32 s10, s10, 0x7fff
    s_add_u32 s10, s10, s9
    buffer_load_dwordx4 v[228:231], v4, s[44:47], s10 offen nt
    s_add_u32 s10, s83, 30720
    s_and_b32 s10, s10, 0x7fff
    s_add_u32 s10, s10, s9
    buffer_load_dwordx4 v[232:235], v4, s[44:47], s10 offen nt
    s_add_u32 s10, s83, 31744
    s_and_b32 s10, s10, 0x7fff
    s_add_u32 s10, s10, s9
    buffer_load_dwordx4 v[236:239], v4, s[44:47], s10 offen nt
    v_add_f32_dpp v60, v60, v60 row_ror:8 row_mask:0xf bank_mask:0xf
    v_add_f32_dpp v61, v61, v61 row_ror:8 row_mask:0xf bank_mask:0xf
    v_add_f32_dpp v62, v62, v62 row_ror:8 row_mask:0xf bank_mask:0xf
    v_add_f32_dpp v63, v63, v63 row_ror:8 row_mask:0xf bank_mask:0xf
    v_add_f32_dpp v60, v60, v60 row_ror:4 row_mask:0xf bank_mask:0xf
    v_add_f32_dpp v61, v61, v61 row_ror:4 row_mask:0xf bank_mask:0xf
    v_add_f32_dpp v62, v62, v62 row_ror:4 row_mask:0xf bank_mask:0xf
    v_add_f32_dpp v63, v63, v63 row_ror:4 row_mask:0xf bank_mask:0xf
    v_add_f32_dpp v60, v60, v60 row_ror:2 row_mask:0xf bank_mask:0xf
    v_add_f32_dpp v61, v61, v61 row_ror:2 row_mask:0xf bank_mask:0xf
    v_add_f32_dpp v62, v62, v62 row_ror:2 row_mask:0xf bank_mask:0xf
    v_add_f32_dpp v63, v63, v63 row_ror:2 row_mask:0xf bank_mask:0xf
    v_add_f32_dpp v60, v60, v60 row_ror:1 row_mask:0xf bank_mask:0xf
    v_add_f32_dpp v61, v61, v61 row_ror:1 row_mask:0xf bank_mask:0xf
    v_add_f32_dpp v62, v62, v62 row_ror:1 row_mask:0xf bank_mask:0xf
    v_add_f32_dpp v63, v63, v63 row_ror:1 row_mask:0xf bank_mask:0xf
    v_cvt_pk_bf16_f32 v20, v60, v60
    v_cvt_pk_bf16_f32 v21, v61, v61
    v_cvt_pk_bf16_f32 v22, v62, v62
    v_cvt_pk_bf16_f32 v23, v63, v63
    v_lshlrev_b32 v60, 16, v20
    v_lshlrev_b32 v61, 16, v21
    v_lshlrev_b32 v62, 16, v22
    v_lshlrev_b32 v63, 16, v23
    v_mul_f32 v60, s12, v60
    v_mul_f32 v61, s12, v61
    v_mul_f32 v62, s12, v62
    v_mul_f32 v63, s12, v63
    v_cvt_pk_bf16_f32 v20, v60, v60
    v_cvt_pk_bf16_f32 v21, v61, v61
    v_cvt_pk_bf16_f32 v22, v62, v62
    v_cvt_pk_bf16_f32 v23, v63, v63
    v_lshlrev_b32 v60, 16, v20
    v_lshlrev_b32 v61, 16, v21
    v_lshlrev_b32 v62, 16, v22
    v_lshlrev_b32 v63, 16, v23
    v_lshrrev_b32 v20, 3, v1
    v_and_b32 v21, 7, v1
    s_movk_i32 s10, 1280
    v_mul_lo_u32 v22, v20, s10
    v_lshl_add_u32 v22, v21, 4, v22
    s_lshl_b32 s10, s8, 5
    s_add_u32 s10, s10, s82
    s_mul_i32 s10, s10, 1280
    s_lshl_b32 s11, s81, 7
    s_add_u32 s10, s10, s11
    s_cmp_ge_u32 s2, 250
    s_cselect_b32 s10, 0x7f000000, s10
    buffer_load_dwordx4 v[64:67], v22, s[68:71], s10 offen nt
    s_add_u32 s10, s10, 10240
    buffer_load_dwordx4 v[68:71], v22, s[68:71], s10 offen nt
    s_add_u32 s10, s10, 10240
    buffer_load_dwordx4 v[72:75], v22, s[68:71], s10 offen nt
    s_add_u32 s10, s10, 10240
    buffer_load_dwordx4 v[76:79], v22, s[68:71], s10 offen nt
    s_add_u32 s10, s10, 10240
    v_lshrrev_b32 v20, 2, v1
    v_and_b32 v21, 3, v1
    s_movk_i32 s10, 3456
    v_mul_lo_u32 v22, v20, s10
    v_lshl_add_u32 v22, v21, 4, v22
    v_lshlrev_b32 v23, 1, v20
    s_mul_i32 s10, s8, 80*3456
    s_sub_u32 s11, s2, 202
    s_lshl_b32 s11, s11, 6
    s_add_u32 s10, s10, s11
    s_cmp_lt_u32 s2, 202
    s_cselect_b32 s10, 0x7f000000, s10
    buffer_load_dwordx4 v[80:83], v22, s[60:63], s10 offen nt
    s_add_u32 s10, s10, 55296
    buffer_load_dwordx4 v[84:87], v22, s[60:63], s10 offen nt
    s_add_u32 s10, s10, 55296
    buffer_load_dwordx4 v[88:91], v22, s[60:63], s10 offen nt
    s_add_u32 s10, s10, 55296
    buffer_load_dwordx4 v[92:95], v22, s[60:63], s10 offen nt
    s_add_u32 s10, s10, 55296
    buffer_load_dwordx4 v[96:99], v22, s[60:63], s10 offen nt
    s_add_u32 s10, s10, 55296
    s_mul_i32 s10, s8, 160
    buffer_load_ushort v100, v23, s[52:55], s10 offen offset:0
    buffer_load_ushort v101, v23, s[52:55], s10 offen offset:32
    buffer_load_ushort v102, v23, s[52:55], s10 offen offset:64
    buffer_load_ushort v103, v23, s[52:55], s10 offen offset:96
    buffer_load_ushort v104, v23, s[52:55], s10 offen offset:128
    buffer_load_ushort v105, v23, s[52:55], s10 offen offset:1280
    buffer_load_ushort v106, v23, s[52:55], s10 offen offset:1312
    buffer_load_ushort v107, v23, s[52:55], s10 offen offset:1344
    buffer_load_ushort v108, v23, s[52:55], s10 offen offset:1376
    buffer_load_ushort v109, v23, s[52:55], s10 offen offset:1408
    v_mov_b32 v22, 20480
    ds_read_b32 v23, v22
    s_waitcnt lgkmcnt(0)
    v_readfirstlane_b32 s101, v23
    v_max3_f32 v28, v32, v33, v34
    v_max3_f32 v28, v28, v35, v36
    v_max3_f32 v28, v28, v37, v38
    v_max3_f32 v28, v28, v39, v40
    v_max3_f32 v28, v28, v41, v42
    v_max3_f32 v28, v28, v43, v44
    v_max3_f32 v28, v28, v45, v46
    v_max3_f32 v28, v28, v47, v48
    v_max3_f32 v28, v28, v49, v50
    v_max3_f32 v28, v28, v51, v52
    v_max3_f32 v28, v28, v53, v54
    v_max3_f32 v28, v28, v55, v56
    v_max3_f32 v28, v28, v57, v58
    v_max3_f32 v28, v28, v59, v60
    v_max3_f32 v28, v28, v61, v62
    v_max_f32 v28, v28, v63
    v_mov_b32 v20, v28
    s_nop 1
    v_permlane16_swap_b32 v28, v20
    s_nop 1
    v_max_f32 v28, v28, v20
    v_mov_b32 v20, v28
    s_nop 1
    v_permlane32_swap_b32 v28, v20
    s_nop 1
    v_max_f32 v28, v28, v20
    v_mul_f32 v29, s13, v28
    v_fma_f32 v32, v32, s13, -v29
    v_fma_f32 v33, v33, s13, -v29
    v_fma_f32 v34, v34, s13, -v29
    v_fma_f32 v35, v35, s13, -v29
    v_fma_f32 v36, v36, s13, -v29
    v_fma_f32 v37, v37, s13, -v29
    v_fma_f32 v38, v38, s13, -v29
    v_fma_f32 v39, v39, s13, -v29
    v_fma_f32 v40, v40, s13, -v29
    v_fma_f32 v41, v41, s13, -v29
    v_fma_f32 v42, v42, s13, -v29
    v_fma_f32 v43, v43, s13, -v29
    v_fma_f32 v44, v44, s13, -v29
    v_fma_f32 v45, v45, s13, -v29
    v_fma_f32 v46, v46, s13, -v29
    v_fma_f32 v47, v47, s13, -v29
    v_fma_f32 v48, v48, s13, -v29
    v_fma_f32 v49, v49, s13, -v29
    v_fma_f32 v50, v50, s13, -v29
    v_fma_f32 v51, v51, s13, -v29
    v_fma_f32 v52, v52, s13, -v29
    v_fma_f32 v53, v53, s13, -v29
    v_fma_f32 v54, v54, s13, -v29
    v_fma_f32 v55, v55, s13, -v29
    v_fma_f32 v56, v56, s13, -v29
    v_fma_f32 v57, v57, s13, -v29
    v_fma_f32 v58, v58, s13, -v29
    v_fma_f32 v59, v59, s13, -v29
    v_fma_f32 v60, v60, s13, -v29
    v_fma_f32 v61, v61, s13, -v29
    v_fma_f32 v62, v62, s13, -v29
    v_fma_f32 v63, v63, s13, -v29
    v_exp_f32 v32, v32
    v_exp_f32 v33, v33
    v_exp_f32 v34, v34
    v_exp_f32 v35, v35
    v_exp_f32 v36, v36
    v_exp_f32 v37, v37
    v_exp_f32 v38, v38
    v_exp_f32 v39, v39
    v_exp_f32 v40, v40
    v_exp_f32 v41, v41
    v_exp_f32 v42, v42
    v_exp_f32 v43, v43
    v_exp_f32 v44, v44
    v_exp_f32 v45, v45
    v_exp_f32 v46, v46
    v_exp_f32 v47, v47
    v_exp_f32 v48, v48
    v_exp_f32 v49, v49
    v_exp_f32 v50, v50
    v_exp_f32 v51, v51
    v_exp_f32 v52, v52
    v_exp_f32 v53, v53
    v_exp_f32 v54, v54
    v_exp_f32 v55, v55
    v_exp_f32 v56, v56
    v_exp_f32 v57, v57
    v_exp_f32 v58, v58
    v_exp_f32 v59, v59
    v_exp_f32 v60, v60
    v_exp_f32 v61, v61
    v_exp_f32 v62, v62
    v_exp_f32 v63, v63
    s_nop 0
    v_add_f32 v30, v32, v33
    v_add_f32 v30, v30, v34
    v_add_f32 v30, v30, v35
    v_add_f32 v30, v30, v36
    v_add_f32 v30, v30, v37
    v_add_f32 v30, v30, v38
    v_add_f32 v30, v30, v39
    v_add_f32 v30, v30, v40
    v_add_f32 v30, v30, v41
    v_add_f32 v30, v30, v42
    v_add_f32 v30, v30, v43
    v_add_f32 v30, v30, v44
    v_add_f32 v30, v30, v45
    v_add_f32 v30, v30, v46
    v_add_f32 v30, v30, v47
    v_add_f32 v30, v30, v48
    v_add_f32 v30, v30, v49
    v_add_f32 v30, v30, v50
    v_add_f32 v30, v30, v51
    v_add_f32 v30, v30, v52
    v_add_f32 v30, v30, v53
    v_add_f32 v30, v30, v54
    v_add_f32 v30, v30, v55
    v_add_f32 v30, v30, v56
    v_add_f32 v30, v30, v57
    v_add_f32 v30, v30, v58
    v_add_f32 v30, v30, v59
    v_add_f32 v30, v30, v60
    v_add_f32 v30, v30, v61
    v_add_f32 v30, v30, v62
    v_add_f32 v30, v30, v63
    v_mov_b32 v20, v30
    s_nop 1
    v_permlane16_swap_b32 v30, v20
    s_nop 1
    v_add_f32 v30, v30, v20
    v_mov_b32 v20, v30
    s_nop 1
    v_permlane32_swap_b32 v30, v20
    s_nop 1
    v_add_f32 v30, v30, v20
    v_mov_b32 v8, 0
    v_mov_b32 v9, 0
    v_mov_b32 v10, 0
    v_mov_b32 v11, 0
    v_mov_b32 v12, 0
    v_mov_b32 v13, 0
    v_mov_b32 v14, 0
    v_mov_b32 v15, 0
    s_waitcnt vmcnt(50)
    v_lshlrev_b32 v22, 16, v112
    v_and_b32 v23, 0xffff0000, v112
    v_fmac_f32 v8, v32, v22
    v_fmac_f32 v9, v32, v23
    v_lshlrev_b32 v22, 16, v113
    v_and_b32 v23, 0xffff0000, v113
    v_fmac_f32 v10, v32, v22
    v_fmac_f32 v11, v32, v23
    v_lshlrev_b32 v22, 16, v114
    v_and_b32 v23, 0xffff0000, v114
    v_fmac_f32 v12, v32, v22
    v_fmac_f32 v13, v32, v23
    v_lshlrev_b32 v22, 16, v115
    v_and_b32 v23, 0xffff0000, v115
    v_fmac_f32 v14, v32, v22
    v_fmac_f32 v15, v32, v23
    s_waitcnt vmcnt(49)
    v_lshlrev_b32 v22, 16, v116
    v_and_b32 v23, 0xffff0000, v116
    v_fmac_f32 v8, v33, v22
    v_fmac_f32 v9, v33, v23
    v_lshlrev_b32 v22, 16, v117
    v_and_b32 v23, 0xffff0000, v117
    v_fmac_f32 v10, v33, v22
    v_fmac_f32 v11, v33, v23
    v_lshlrev_b32 v22, 16, v118
    v_and_b32 v23, 0xffff0000, v118
    v_fmac_f32 v12, v33, v22
    v_fmac_f32 v13, v33, v23
    v_lshlrev_b32 v22, 16, v119
    v_and_b32 v23, 0xffff0000, v119
    v_fmac_f32 v14, v33, v22
    v_fmac_f32 v15, v33, v23
    s_waitcnt vmcnt(48)
    v_lshlrev_b32 v22, 16, v120
    v_and_b32 v23, 0xffff0000, v120
    v_fmac_f32 v8, v34, v22
    v_fmac_f32 v9, v34, v23
    v_lshlrev_b32 v22, 16, v121
    v_and_b32 v23, 0xffff0000, v121
    v_fmac_f32 v10, v34, v22
    v_fmac_f32 v11, v34, v23
    v_lshlrev_b32 v22, 16, v122
    v_and_b32 v23, 0xffff0000, v122
    v_fmac_f32 v12, v34, v22
    v_fmac_f32 v13, v34, v23
    v_lshlrev_b32 v22, 16, v123
    v_and_b32 v23, 0xffff0000, v123
    v_fmac_f32 v14, v34, v22
    v_fmac_f32 v15, v34, v23
    s_waitcnt vmcnt(47)
    v_lshlrev_b32 v22, 16, v124
    v_and_b32 v23, 0xffff0000, v124
    v_fmac_f32 v8, v35, v22
    v_fmac_f32 v9, v35, v23
    v_lshlrev_b32 v22, 16, v125
    v_and_b32 v23, 0xffff0000, v125
    v_fmac_f32 v10, v35, v22
    v_fmac_f32 v11, v35, v23
    v_lshlrev_b32 v22, 16, v126
    v_and_b32 v23, 0xffff0000, v126
    v_fmac_f32 v12, v35, v22
    v_fmac_f32 v13, v35, v23
    v_lshlrev_b32 v22, 16, v127
    v_and_b32 v23, 0xffff0000, v127
    v_fmac_f32 v14, v35, v22
    v_fmac_f32 v15, v35, v23
    s_waitcnt vmcnt(46)
    v_lshlrev_b32 v22, 16, v128
    v_and_b32 v23, 0xffff0000, v128
    v_fmac_f32 v8, v36, v22
    v_fmac_f32 v9, v36, v23
    v_lshlrev_b32 v22, 16, v129
    v_and_b32 v23, 0xffff0000, v129
    v_fmac_f32 v10, v36, v22
    v_fmac_f32 v11, v36, v23
    v_lshlrev_b32 v22, 16, v130
    v_and_b32 v23, 0xffff0000, v130
    v_fmac_f32 v12, v36, v22
    v_fmac_f32 v13, v36, v23
    v_lshlrev_b32 v22, 16, v131
    v_and_b32 v23, 0xffff0000, v131
    v_fmac_f32 v14, v36, v22
    v_fmac_f32 v15, v36, v23
    s_waitcnt vmcnt(45)
    v_lshlrev_b32 v22, 16, v132
    v_and_b32 v23, 0xffff0000, v132
    v_fmac_f32 v8, v37, v22
    v_fmac_f32 v9, v37, v23
    v_lshlrev_b32 v22, 16, v133
    v_and_b32 v23, 0xffff0000, v133
    v_fmac_f32 v10, v37, v22
    v_fmac_f32 v11, v37, v23
    v_lshlrev_b32 v22, 16, v134
    v_and_b32 v23, 0xffff0000, v134
    v_fmac_f32 v12, v37, v22
    v_fmac_f32 v13, v37, v23
    v_lshlrev_b32 v22, 16, v135
    v_and_b32 v23, 0xffff0000, v135
    v_fmac_f32 v14, v37, v22
    v_fmac_f32 v15, v37, v23
    s_waitcnt vmcnt(44)
    v_lshlrev_b32 v22, 16, v136
    v_and_b32 v23, 0xffff0000, v136
    v_fmac_f32 v8, v38, v22
    v_fmac_f32 v9, v38, v23
    v_lshlrev_b32 v22, 16, v137
    v_and_b32 v23, 0xffff0000, v137
    v_fmac_f32 v10, v38, v22
    v_fmac_f32 v11, v38, v23
    v_lshlrev_b32 v22, 16, v138
    v_and_b32 v23, 0xffff0000, v138
    v_fmac_f32 v12, v38, v22
    v_fmac_f32 v13, v38, v23
    v_lshlrev_b32 v22, 16, v139
    v_and_b32 v23, 0xffff0000, v139
    v_fmac_f32 v14, v38, v22
    v_fmac_f32 v15, v38, v23
    s_waitcnt vmcnt(43)
    v_lshlrev_b32 v22, 16, v140
    v_and_b32 v23, 0xffff0000, v140
    v_fmac_f32 v8, v39, v22
    v_fmac_f32 v9, v39, v23
    v_lshlrev_b32 v22, 16, v141
    v_and_b32 v23, 0xffff0000, v141
    v_fmac_f32 v10, v39, v22
    v_fmac_f32 v11, v39, v23
    v_lshlrev_b32 v22, 16, v142
    v_and_b32 v23, 0xffff0000, v142
    v_fmac_f32 v12, v39, v22
    v_fmac_f32 v13, v39, v23
    v_lshlrev_b32 v22, 16, v143
    v_and_b32 v23, 0xffff0000, v143
    v_fmac_f32 v14, v39, v22
    v_fmac_f32 v15, v39, v23
    s_waitcnt vmcnt(42)
    v_lshlrev_b32 v22, 16, v144
    v_and_b32 v23, 0xffff0000, v144
    v_fmac_f32 v8, v40, v22
    v_fmac_f32 v9, v40, v23
    v_lshlrev_b32 v22, 16, v145
    v_and_b32 v23, 0xffff0000, v145
    v_fmac_f32 v10, v40, v22
    v_fmac_f32 v11, v40, v23
    v_lshlrev_b32 v22, 16, v146
    v_and_b32 v23, 0xffff0000, v146
    v_fmac_f32 v12, v40, v22
    v_fmac_f32 v13, v40, v23
    v_lshlrev_b32 v22, 16, v147
    v_and_b32 v23, 0xffff0000, v147
    v_fmac_f32 v14, v40, v22
    v_fmac_f32 v15, v40, v23
    s_waitcnt vmcnt(41)
    v_lshlrev_b32 v22, 16, v148
    v_and_b32 v23, 0xffff0000, v148
    v_fmac_f32 v8, v41, v22
    v_fmac_f32 v9, v41, v23
    v_lshlrev_b32 v22, 16, v149
    v_and_b32 v23, 0xffff0000, v149
    v_fmac_f32 v10, v41, v22
    v_fmac_f32 v11, v41, v23
    v_lshlrev_b32 v22, 16, v150
    v_and_b32 v23, 0xffff0000, v150
    v_fmac_f32 v12, v41, v22
    v_fmac_f32 v13, v41, v23
    v_lshlrev_b32 v22, 16, v151
    v_and_b32 v23, 0xffff0000, v151
    v_fmac_f32 v14, v41, v22
    v_fmac_f32 v15, v41, v23
    s_waitcnt vmcnt(40)
    v_lshlrev_b32 v22, 16, v152
    v_and_b32 v23, 0xffff0000, v152
    v_fmac_f32 v8, v42, v22
    v_fmac_f32 v9, v42, v23
    v_lshlrev_b32 v22, 16, v153
    v_and_b32 v23, 0xffff0000, v153
    v_fmac_f32 v10, v42, v22
    v_fmac_f32 v11, v42, v23
    v_lshlrev_b32 v22, 16, v154
    v_and_b32 v23, 0xffff0000, v154
    v_fmac_f32 v12, v42, v22
    v_fmac_f32 v13, v42, v23
    v_lshlrev_b32 v22, 16, v155
    v_and_b32 v23, 0xffff0000, v155
    v_fmac_f32 v14, v42, v22
    v_fmac_f32 v15, v42, v23
    s_waitcnt vmcnt(39)
    v_lshlrev_b32 v22, 16, v156
    v_and_b32 v23, 0xffff0000, v156
    v_fmac_f32 v8, v43, v22
    v_fmac_f32 v9, v43, v23
    v_lshlrev_b32 v22, 16, v157
    v_and_b32 v23, 0xffff0000, v157
    v_fmac_f32 v10, v43, v22
    v_fmac_f32 v11, v43, v23
    v_lshlrev_b32 v22, 16, v158
    v_and_b32 v23, 0xffff0000, v158
    v_fmac_f32 v12, v43, v22
    v_fmac_f32 v13, v43, v23
    v_lshlrev_b32 v22, 16, v159
    v_and_b32 v23, 0xffff0000, v159
    v_fmac_f32 v14, v43, v22
    v_fmac_f32 v15, v43, v23
    s_waitcnt vmcnt(38)
    v_lshlrev_b32 v22, 16, v160
    v_and_b32 v23, 0xffff0000, v160
    v_fmac_f32 v8, v44, v22
    v_fmac_f32 v9, v44, v23
    v_lshlrev_b32 v22, 16, v161
    v_and_b32 v23, 0xffff0000, v161
    v_fmac_f32 v10, v44, v22
    v_fmac_f32 v11, v44, v23
    v_lshlrev_b32 v22, 16, v162
    v_and_b32 v23, 0xffff0000, v162
    v_fmac_f32 v12, v44, v22
    v_fmac_f32 v13, v44, v23
    v_lshlrev_b32 v22, 16, v163
    v_and_b32 v23, 0xffff0000, v163
    v_fmac_f32 v14, v44, v22
    v_fmac_f32 v15, v44, v23
    s_waitcnt vmcnt(37)
    v_lshlrev_b32 v22, 16, v164
    v_and_b32 v23, 0xffff0000, v164
    v_fmac_f32 v8, v45, v22
    v_fmac_f32 v9, v45, v23
    v_lshlrev_b32 v22, 16, v165
    v_and_b32 v23, 0xffff0000, v165
    v_fmac_f32 v10, v45, v22
    v_fmac_f32 v11, v45, v23
    v_lshlrev_b32 v22, 16, v166
    v_and_b32 v23, 0xffff0000, v166
    v_fmac_f32 v12, v45, v22
    v_fmac_f32 v13, v45, v23
    v_lshlrev_b32 v22, 16, v167
    v_and_b32 v23, 0xffff0000, v167
    v_fmac_f32 v14, v45, v22
    v_fmac_f32 v15, v45, v23
    s_waitcnt vmcnt(36)
    v_lshlrev_b32 v22, 16, v168
    v_and_b32 v23, 0xffff0000, v168
    v_fmac_f32 v8, v46, v22
    v_fmac_f32 v9, v46, v23
    v_lshlrev_b32 v22, 16, v169
    v_and_b32 v23, 0xffff0000, v169
    v_fmac_f32 v10, v46, v22
    v_fmac_f32 v11, v46, v23
    v_lshlrev_b32 v22, 16, v170
    v_and_b32 v23, 0xffff0000, v170
    v_fmac_f32 v12, v46, v22
    v_fmac_f32 v13, v46, v23
    v_lshlrev_b32 v22, 16, v171
    v_and_b32 v23, 0xffff0000, v171
    v_fmac_f32 v14, v46, v22
    v_fmac_f32 v15, v46, v23
    s_waitcnt vmcnt(35)
    v_lshlrev_b32 v22, 16, v172
    v_and_b32 v23, 0xffff0000, v172
    v_fmac_f32 v8, v47, v22
    v_fmac_f32 v9, v47, v23
    v_lshlrev_b32 v22, 16, v173
    v_and_b32 v23, 0xffff0000, v173
    v_fmac_f32 v10, v47, v22
    v_fmac_f32 v11, v47, v23
    v_lshlrev_b32 v22, 16, v174
    v_and_b32 v23, 0xffff0000, v174
    v_fmac_f32 v12, v47, v22
    v_fmac_f32 v13, v47, v23
    v_lshlrev_b32 v22, 16, v175
    v_and_b32 v23, 0xffff0000, v175
    v_fmac_f32 v14, v47, v22
    v_fmac_f32 v15, v47, v23
    s_waitcnt vmcnt(34)
    v_lshlrev_b32 v22, 16, v176
    v_and_b32 v23, 0xffff0000, v176
    v_fmac_f32 v8, v48, v22
    v_fmac_f32 v9, v48, v23
    v_lshlrev_b32 v22, 16, v177
    v_and_b32 v23, 0xffff0000, v177
    v_fmac_f32 v10, v48, v22
    v_fmac_f32 v11, v48, v23
    v_lshlrev_b32 v22, 16, v178
    v_and_b32 v23, 0xffff0000, v178
    v_fmac_f32 v12, v48, v22
    v_fmac_f32 v13, v48, v23
    v_lshlrev_b32 v22, 16, v179
    v_and_b32 v23, 0xffff0000, v179
    v_fmac_f32 v14, v48, v22
    v_fmac_f32 v15, v48, v23
    s_waitcnt vmcnt(33)
    v_lshlrev_b32 v22, 16, v180
    v_and_b32 v23, 0xffff0000, v180
    v_fmac_f32 v8, v49, v22
    v_fmac_f32 v9, v49, v23
    v_lshlrev_b32 v22, 16, v181
    v_and_b32 v23, 0xffff0000, v181
    v_fmac_f32 v10, v49, v22
    v_fmac_f32 v11, v49, v23
    v_lshlrev_b32 v22, 16, v182
    v_and_b32 v23, 0xffff0000, v182
    v_fmac_f32 v12, v49, v22
    v_fmac_f32 v13, v49, v23
    v_lshlrev_b32 v22, 16, v183
    v_and_b32 v23, 0xffff0000, v183
    v_fmac_f32 v14, v49, v22
    v_fmac_f32 v15, v49, v23
    s_waitcnt vmcnt(32)
    v_lshlrev_b32 v22, 16, v184
    v_and_b32 v23, 0xffff0000, v184
    v_fmac_f32 v8, v50, v22
    v_fmac_f32 v9, v50, v23
    v_lshlrev_b32 v22, 16, v185
    v_and_b32 v23, 0xffff0000, v185
    v_fmac_f32 v10, v50, v22
    v_fmac_f32 v11, v50, v23
    v_lshlrev_b32 v22, 16, v186
    v_and_b32 v23, 0xffff0000, v186
    v_fmac_f32 v12, v50, v22
    v_fmac_f32 v13, v50, v23
    v_lshlrev_b32 v22, 16, v187
    v_and_b32 v23, 0xffff0000, v187
    v_fmac_f32 v14, v50, v22
    v_fmac_f32 v15, v50, v23
    s_waitcnt vmcnt(31)
    v_lshlrev_b32 v22, 16, v188
    v_and_b32 v23, 0xffff0000, v188
    v_fmac_f32 v8, v51, v22
    v_fmac_f32 v9, v51, v23
    v_lshlrev_b32 v22, 16, v189
    v_and_b32 v23, 0xffff0000, v189
    v_fmac_f32 v10, v51, v22
    v_fmac_f32 v11, v51, v23
    v_lshlrev_b32 v22, 16, v190
    v_and_b32 v23, 0xffff0000, v190
    v_fmac_f32 v12, v51, v22
    v_fmac_f32 v13, v51, v23
    v_lshlrev_b32 v22, 16, v191
    v_and_b32 v23, 0xffff0000, v191
    v_fmac_f32 v14, v51, v22
    v_fmac_f32 v15, v51, v23
    s_waitcnt vmcnt(30)
    v_lshlrev_b32 v22, 16, v192
    v_and_b32 v23, 0xffff0000, v192
    v_fmac_f32 v8, v52, v22
    v_fmac_f32 v9, v52, v23
    v_lshlrev_b32 v22, 16, v193
    v_and_b32 v23, 0xffff0000, v193
    v_fmac_f32 v10, v52, v22
    v_fmac_f32 v11, v52, v23
    v_lshlrev_b32 v22, 16, v194
    v_and_b32 v23, 0xffff0000, v194
    v_fmac_f32 v12, v52, v22
    v_fmac_f32 v13, v52, v23
    v_lshlrev_b32 v22, 16, v195
    v_and_b32 v23, 0xffff0000, v195
    v_fmac_f32 v14, v52, v22
    v_fmac_f32 v15, v52, v23
    s_waitcnt vmcnt(29)
    v_lshlrev_b32 v22, 16, v196
    v_and_b32 v23, 0xffff0000, v196
    v_fmac_f32 v8, v53, v22
    v_fmac_f32 v9, v53, v23
    v_lshlrev_b32 v22, 16, v197
    v_and_b32 v23, 0xffff0000, v197
    v_fmac_f32 v10, v53, v22
    v_fmac_f32 v11, v53, v23
    v_lshlrev_b32 v22, 16, v198
    v_and_b32 v23, 0xffff0000, v198
    v_fmac_f32 v12, v53, v22
    v_fmac_f32 v13, v53, v23
    v_lshlrev_b32 v22, 16, v199
    v_and_b32 v23, 0xffff0000, v199
    v_fmac_f32 v14, v53, v22
    v_fmac_f32 v15, v53, v23
    s_waitcnt vmcnt(28)
    v_lshlrev_b32 v22, 16, v200
    v_and_b32 v23, 0xffff0000, v200
    v_fmac_f32 v8, v54, v22
    v_fmac_f32 v9, v54, v23
    v_lshlrev_b32 v22, 16, v201
    v_and_b32 v23, 0xffff0000, v201
    v_fmac_f32 v10, v54, v22
    v_fmac_f32 v11, v54, v23
    v_lshlrev_b32 v22, 16, v202
    v_and_b32 v23, 0xffff0000, v202
    v_fmac_f32 v12, v54, v22
    v_fmac_f32 v13, v54, v23
    v_lshlrev_b32 v22, 16, v203
    v_and_b32 v23, 0xffff0000, v203
    v_fmac_f32 v14, v54, v22
    v_fmac_f32 v15, v54, v23
    s_waitcnt vmcnt(27)
    v_lshlrev_b32 v22, 16, v204
    v_and_b32 v23, 0xffff0000, v204
    v_fmac_f32 v8, v55, v22
    v_fmac_f32 v9, v55, v23
    v_lshlrev_b32 v22, 16, v205
    v_and_b32 v23, 0xffff0000, v205
    v_fmac_f32 v10, v55, v22
    v_fmac_f32 v11, v55, v23
    v_lshlrev_b32 v22, 16, v206
    v_and_b32 v23, 0xffff0000, v206
    v_fmac_f32 v12, v55, v22
    v_fmac_f32 v13, v55, v23
    v_lshlrev_b32 v22, 16, v207
    v_and_b32 v23, 0xffff0000, v207
    v_fmac_f32 v14, v55, v22
    v_fmac_f32 v15, v55, v23
    s_waitcnt vmcnt(26)
    v_lshlrev_b32 v22, 16, v208
    v_and_b32 v23, 0xffff0000, v208
    v_fmac_f32 v8, v56, v22
    v_fmac_f32 v9, v56, v23
    v_lshlrev_b32 v22, 16, v209
    v_and_b32 v23, 0xffff0000, v209
    v_fmac_f32 v10, v56, v22
    v_fmac_f32 v11, v56, v23
    v_lshlrev_b32 v22, 16, v210
    v_and_b32 v23, 0xffff0000, v210
    v_fmac_f32 v12, v56, v22
    v_fmac_f32 v13, v56, v23
    v_lshlrev_b32 v22, 16, v211
    v_and_b32 v23, 0xffff0000, v211
    v_fmac_f32 v14, v56, v22
    v_fmac_f32 v15, v56, v23
    s_waitcnt vmcnt(25)
    v_lshlrev_b32 v22, 16, v212
    v_and_b32 v23, 0xffff0000, v212
    v_fmac_f32 v8, v57, v22
    v_fmac_f32 v9, v57, v23
    v_lshlrev_b32 v22, 16, v213
    v_and_b32 v23, 0xffff0000, v213
    v_fmac_f32 v10, v57, v22
    v_fmac_f32 v11, v57, v23
    v_lshlrev_b32 v22, 16, v214
    v_and_b32 v23, 0xffff0000, v214
    v_fmac_f32 v12, v57, v22
    v_fmac_f32 v13, v57, v23
    v_lshlrev_b32 v22, 16, v215
    v_and_b32 v23, 0xffff0000, v215
    v_fmac_f32 v14, v57, v22
    v_fmac_f32 v15, v57, v23
    s_waitcnt vmcnt(24)
    v_lshlrev_b32 v22, 16, v216
    v_and_b32 v23, 0xffff0000, v216
    v_fmac_f32 v8, v58, v22
    v_fmac_f32 v9, v58, v23
    v_lshlrev_b32 v22, 16, v217
    v_and_b32 v23, 0xffff0000, v217
    v_fmac_f32 v10, v58, v22
    v_fmac_f32 v11, v58, v23
    v_lshlrev_b32 v22, 16, v218
    v_and_b32 v23, 0xffff0000, v218
    v_fmac_f32 v12, v58, v22
    v_fmac_f32 v13, v58, v23
    v_lshlrev_b32 v22, 16, v219
    v_and_b32 v23, 0xffff0000, v219
    v_fmac_f32 v14, v58, v22
    v_fmac_f32 v15, v58, v23
    s_waitcnt vmcnt(23)
    v_lshlrev_b32 v22, 16, v220
    v_and_b32 v23, 0xffff0000, v220
    v_fmac_f32 v8, v59, v22
    v_fmac_f32 v9, v59, v23
    v_lshlrev_b32 v22, 16, v221
    v_and_b32 v23, 0xffff0000, v221
    v_fmac_f32 v10, v59, v22
    v_fmac_f32 v11, v59, v23
    v_lshlrev_b32 v22, 16, v222
    v_and_b32 v23, 0xffff0000, v222
    v_fmac_f32 v12, v59, v22
    v_fmac_f32 v13, v59, v23
    v_lshlrev_b32 v22, 16, v223
    v_and_b32 v23, 0xffff0000, v223
    v_fmac_f32 v14, v59, v22
    v_fmac_f32 v15, v59, v23
    s_waitcnt vmcnt(22)
    v_lshlrev_b32 v22, 16, v224
    v_and_b32 v23, 0xffff0000, v224
    v_fmac_f32 v8, v60, v22
    v_fmac_f32 v9, v60, v23
    v_lshlrev_b32 v22, 16, v225
    v_and_b32 v23, 0xffff0000, v225
    v_fmac_f32 v10, v60, v22
    v_fmac_f32 v11, v60, v23
    v_lshlrev_b32 v22, 16, v226
    v_and_b32 v23, 0xffff0000, v226
    v_fmac_f32 v12, v60, v22
    v_fmac_f32 v13, v60, v23
    v_lshlrev_b32 v22, 16, v227
    v_and_b32 v23, 0xffff0000, v227
    v_fmac_f32 v14, v60, v22
    v_fmac_f32 v15, v60, v23
    s_waitcnt vmcnt(21)
    v_lshlrev_b32 v22, 16, v228
    v_and_b32 v23, 0xffff0000, v228
    v_fmac_f32 v8, v61, v22
    v_fmac_f32 v9, v61, v23
    v_lshlrev_b32 v22, 16, v229
    v_and_b32 v23, 0xffff0000, v229
    v_fmac_f32 v10, v61, v22
    v_fmac_f32 v11, v61, v23
    v_lshlrev_b32 v22, 16, v230
    v_and_b32 v23, 0xffff0000, v230
    v_fmac_f32 v12, v61, v22
    v_fmac_f32 v13, v61, v23
    v_lshlrev_b32 v22, 16, v231
    v_and_b32 v23, 0xffff0000, v231
    v_fmac_f32 v14, v61, v22
    v_fmac_f32 v15, v61, v23
    s_waitcnt vmcnt(20)
    v_lshlrev_b32 v22, 16, v232
    v_and_b32 v23, 0xffff0000, v232
    v_fmac_f32 v8, v62, v22
    v_fmac_f32 v9, v62, v23
    v_lshlrev_b32 v22, 16, v233
    v_and_b32 v23, 0xffff0000, v233
    v_fmac_f32 v10, v62, v22
    v_fmac_f32 v11, v62, v23
    v_lshlrev_b32 v22, 16, v234
    v_and_b32 v23, 0xffff0000, v234
    v_fmac_f32 v12, v62, v22
    v_fmac_f32 v13, v62, v23
    v_lshlrev_b32 v22, 16, v235
    v_and_b32 v23, 0xffff0000, v235
    v_fmac_f32 v14, v62, v22
    v_fmac_f32 v15, v62, v23
    s_waitcnt vmcnt(19)
    v_lshlrev_b32 v22, 16, v236
    v_and_b32 v23, 0xffff0000, v236
    v_fmac_f32 v8, v63, v22
    v_fmac_f32 v9, v63, v23
    v_lshlrev_b32 v22, 16, v237
    v_and_b32 v23, 0xffff0000, v237
    v_fmac_f32 v10, v63, v22
    v_fmac_f32 v11, v63, v23
    v_lshlrev_b32 v22, 16, v238
    v_and_b32 v23, 0xffff0000, v238
    v_fmac_f32 v12, v63, v22
    v_fmac_f32 v13, v63, v23
    v_lshlrev_b32 v22, 16, v239
    v_and_b32 v23, 0xffff0000, v239
    v_fmac_f32 v14, v63, v22
    v_fmac_f32 v15, v63, v23
    v_mov_b32 v20, v8
    v_mov_b32 v21, v9
    v_mov_b32 v22, v10
    v_mov_b32 v23, v11
    v_mov_b32 v24, v12
    v_mov_b32 v25, v13
    v_mov_b32 v26, v14
    v_mov_b32 v27, v15
    s_nop 1
    v_permlane16_swap_b32 v8, v20
    v_permlane16_swap_b32 v9, v21
    v_permlane16_swap_b32 v10, v22
    v_permlane16_swap_b32 v11, v23
    v_permlane16_swap_b32 v12, v24
    v_permlane16_swap_b32 v13, v25
    v_permlane16_swap_b32 v14, v26
    v_permlane16_swap_b32 v15, v27
    s_nop 1
    v_add_f32 v8, v8, v20
    v_add_f32 v9, v9, v21
    v_add_f32 v10, v10, v22
    v_add_f32 v11, v11, v23
    v_add_f32 v12, v12, v24
    v_add_f32 v13, v13, v25
    v_add_f32 v14, v14, v26
    v_add_f32 v15, v15, v27
    v_mov_b32 v20, v8
    v_mov_b32 v21, v9
    v_mov_b32 v22, v10
    v_mov_b32 v23, v11
    v_mov_b32 v24, v12
    v_mov_b32 v25, v13
    v_mov_b32 v26, v14
    v_mov_b32 v27, v15
    s_nop 1
    v_permlane32_swap_b32 v8, v20
    v_permlane32_swap_b32 v9, v21
    v_permlane32_swap_b32 v10, v22
    v_permlane32_swap_b32 v11, v23
    v_permlane32_swap_b32 v12, v24
    v_permlane32_swap_b32 v13, v25
    v_permlane32_swap_b32 v14, v26
    v_permlane32_swap_b32 v15, v27
    s_nop 1
    v_add_f32 v8, v8, v20
    v_add_f32 v9, v9, v21
    v_add_f32 v10, v10, v22
    v_add_f32 v11, v11, v23
    v_add_f32 v12, v12, v24
    v_add_f32 v13, v13, v25
    v_add_f32 v14, v14, v26
    v_add_f32 v15, v15, v27
    v_lshlrev_b32 v20, 1, v2
    s_lshl_b32 s10, s8, 9
    v_add_u32 v21, s10, v20
    ds_write_b128 v21, v[8:11] offset:4096
    ds_write_b128 v21, v[12:15] offset:4112
    s_lshl_b32 s10, s8, 3
    v_mov_b32 v22, s10
    v_mov_b32 v29, v30
    ds_write_b64 v22, v[28:29] offset:8192
    s_waitcnt lgkmcnt(0)
    s_barrier
    s_cmp_eq_u32 s8, 0
    s_cbranch_scc1 L_gate
    s_cmp_lg_u32 s8, 1
    s_cbranch_scc1 L_mlp
    v_mov_b32 v22, 0
    ds_read_b128 v[112:115], v22 offset:8192
    ds_read_b128 v[116:119], v22 offset:8208
    ds_read_b128 v[120:123], v22 offset:8224
    ds_read_b128 v[124:127], v22 offset:8240
    ds_read_b128 v[128:131], v20 offset:4096
    ds_read_b128 v[132:135], v20 offset:4112
    ds_read_b128 v[136:139], v20 offset:4608
    ds_read_b128 v[140:143], v20 offset:4624
    ds_read_b128 v[144:147], v20 offset:5120
    ds_read_b128 v[148:151], v20 offset:5136
    ds_read_b128 v[152:155], v20 offset:5632
    ds_read_b128 v[156:159], v20 offset:5648
    ds_read_b128 v[160:163], v20 offset:6144
    ds_read_b128 v[164:167], v20 offset:6160
    ds_read_b128 v[168:171], v20 offset:6656
    ds_read_b128 v[172:175], v20 offset:6672
    ds_read_b128 v[176:179], v20 offset:7168
    ds_read_b128 v[180:183], v20 offset:7184
    ds_read_b128 v[184:187], v20 offset:7680
    ds_read_b128 v[188:191], v20 offset:7696
    s_waitcnt lgkmcnt(0)
    v_max3_f32 v28, v112, v114, v116
    v_max3_f32 v28, v28, v118, v120
    v_max3_f32 v28, v28, v122, v124
    v_max_f32 v28, v28, v126
    v_mul_f32 v29, s13, v28
    v_fma_f32 v112, v112, s13, -v29
    v_fma_f32 v114, v114, s13, -v29
    v_fma_f32 v116, v116, s13, -v29
    v_fma_f32 v118, v118, s13, -v29
    v_fma_f32 v120, v120, s13, -v29
    v_fma_f32 v122, v122, s13, -v29
    v_fma_f32 v124, v124, s13, -v29
    v_fma_f32 v126, v126, s13, -v29
    v_exp_f32 v112, v112
    v_exp_f32 v114, v114
    v_exp_f32 v116, v116
    v_exp_f32 v118, v118
    v_exp_f32 v120, v120
    v_exp_f32 v122, v122
    v_exp_f32 v124, v124
    v_exp_f32 v126, v126
    s_nop 0
    v_mul_f32 v29, v112, v113
    v_fmac_f32 v29, v114, v115
    v_fmac_f32 v29, v116, v117
    v_fmac_f32 v29, v118, v119
    v_fmac_f32 v29, v120, v121
    v_fmac_f32 v29, v122, v123
    v_fmac_f32 v29, v124, v125
    v_fmac_f32 v29, v126, v127
    v_mul_f32 v8, v112, v128
    v_mul_f32 v9, v112, v129
    v_mul_f32 v10, v112, v130
    v_mul_f32 v11, v112, v131
    v_mul_f32 v12, v112, v132
    v_mul_f32 v13, v112, v133
    v_mul_f32 v14, v112, v134
    v_mul_f32 v15, v112, v135
    v_fmac_f32 v8, v114, v136
    v_fmac_f32 v9, v114, v137
    v_fmac_f32 v10, v114, v138
    v_fmac_f32 v11, v114, v139
    v_fmac_f32 v12, v114, v140
    v_fmac_f32 v13, v114, v141
    v_fmac_f32 v14, v114, v142
    v_fmac_f32 v15, v114, v143
    v_fmac_f32 v8, v116, v144
    v_fmac_f32 v9, v116, v145
    v_fmac_f32 v10, v116, v146
    v_fmac_f32 v11, v116, v147
    v_fmac_f32 v12, v116, v148
    v_fmac_f32 v13, v116, v149
    v_fmac_f32 v14, v116, v150
    v_fmac_f32 v15, v116, v151
    v_fmac_f32 v8, v118, v152
    v_fmac_f32 v9, v118, v153
    v_fmac_f32 v10, v118, v154
    v_fmac_f32 v11, v118, v155
    v_fmac_f32 v12, v118, v156
    v_fmac_f32 v13, v118, v157
    v_fmac_f32 v14, v118, v158
    v_fmac_f32 v15, v118, v159
    v_fmac_f32 v8, v120, v160
    v_fmac_f32 v9, v120, v161
    v_fmac_f32 v10, v120, v162
    v_fmac_f32 v11, v120, v163
    v_fmac_f32 v12, v120, v164
    v_fmac_f32 v13, v120, v165
    v_fmac_f32 v14, v120, v166
    v_fmac_f32 v15, v120, v167
    v_fmac_f32 v8, v122, v168
    v_fmac_f32 v9, v122, v169
    v_fmac_f32 v10, v122, v170
    v_fmac_f32 v11, v122, v171
    v_fmac_f32 v12, v122, v172
    v_fmac_f32 v13, v122, v173
    v_fmac_f32 v14, v122, v174
    v_fmac_f32 v15, v122, v175
    v_fmac_f32 v8, v124, v176
    v_fmac_f32 v9, v124, v177
    v_fmac_f32 v10, v124, v178
    v_fmac_f32 v11, v124, v179
    v_fmac_f32 v12, v124, v180
    v_fmac_f32 v13, v124, v181
    v_fmac_f32 v14, v124, v182
    v_fmac_f32 v15, v124, v183
    v_fmac_f32 v8, v126, v184
    v_fmac_f32 v9, v126, v185
    v_fmac_f32 v10, v126, v186
    v_fmac_f32 v11, v126, v187
    v_fmac_f32 v12, v126, v188
    v_fmac_f32 v13, v126, v189
    v_fmac_f32 v14, v126, v190
    v_fmac_f32 v15, v126, v191
    s_lshl_b32 s10, s6, 5
    s_add_u32 s10, s10, s3
    s_lshl_b32 s10, s10, 2
    s_add_u32 s10, s10, s7
    s_lshl_b32 s11, s10, 11
    s_add_u32 s11, s11, 1048576
    v_mov_b32 v200, v8
    v_mov_b32 v201, s101
    v_mov_b32 v202, v9
    v_mov_b32 v203, s101
    v_mov_b32 v204, v10
    v_mov_b32 v205, s101
    v_mov_b32 v206, v11
    v_mov_b32 v207, s101
    v_mov_b32 v208, v12
    v_mov_b32 v209, s101
    v_mov_b32 v210, v13
    v_mov_b32 v211, s101
    v_mov_b32 v212, v14
    v_mov_b32 v213, s101
    v_mov_b32 v214, v15
    v_mov_b32 v215, s101
    v_mov_b32 v216, v28
    v_mov_b32 v217, s101
    v_mov_b32 v218, v29
    v_mov_b32 v219, s101
    v_lshlrev_b32 v21, 2, v2
    v_mov_b32 v22, 0
    v_cmp_gt_u32 vcc, 16, v1
    s_and_saveexec_b64 s[14:15], vcc
    buffer_store_dwordx4 v[200:203], v21, s[56:59], s11 offen offset:0 sc1
    buffer_store_dwordx4 v[204:207], v21, s[56:59], s11 offen offset:16 sc1
    buffer_store_dwordx4 v[208:211], v21, s[56:59], s11 offen offset:32 sc1
    buffer_store_dwordx4 v[212:215], v21, s[56:59], s11 offen offset:48 sc1
    s_mov_b64 exec, 1
    buffer_store_dwordx4 v[216:219], v22, s[56:59], s11 offen offset:1024 sc1
    s_mov_b64 exec, s[14:15]
    s_branch L_mlp
L_gate:
    v_lshlrev_b32 v9, 2, v1
    buffer_load_dword v200, v9, s[52:55], 0 offen offset:0
    buffer_load_dword v205, v9, s[52:55], 0 offen offset:1280
    buffer_load_dword v210, v9, s[72:75], 0 offen offset:0
    buffer_load_dword v201, v9, s[52:55], 0 offen offset:256
    buffer_load_dword v206, v9, s[52:55], 0 offen offset:1536
    buffer_load_dword v211, v9, s[72:75], 0 offen offset:256
    buffer_load_dword v202, v9, s[52:55], 0 offen offset:512
    buffer_load_dword v207, v9, s[52:55], 0 offen offset:1792
    buffer_load_dword v212, v9, s[72:75], 0 offen offset:512
    buffer_load_dword v203, v9, s[52:55], 0 offen offset:768
    buffer_load_dword v208, v9, s[52:55], 0 offen offset:2048
    buffer_load_dword v213, v9, s[72:75], 0 offen offset:768
    buffer_load_dword v204, v9, s[52:55], 0 offen offset:1024
    buffer_load_dword v209, v9, s[52:55], 0 offen offset:2304
    buffer_load_dword v214, v9, s[72:75], 0 offen offset:1024
    s_waitcnt vmcnt(0)
    v_mov_b32 v216, 0
    v_mov_b32 v217, 0
    v_lshlrev_b32 v218, 16, v210
    v_lshlrev_b32 v219, 16, v200
    v_lshlrev_b32 v220, 16, v205
    v_mul_f32 v219, v219, v218
    v_mul_f32 v220, v220, v218
    v_cvt_pk_bf16_f32 v221, v219, v219
    v_lshlrev_b32 v219, 16, v221
    v_cvt_pk_bf16_f32 v221, v220, v220
    v_lshlrev_b32 v220, 16, v221
    v_add_f32 v216, v216, v219
    v_add_f32 v217, v217, v220
    v_and_b32 v218, 0xffff0000, v210
    v_and_b32 v219, 0xffff0000, v200
    v_and_b32 v220, 0xffff0000, v205
    v_mul_f32 v219, v219, v218
    v_mul_f32 v220, v220, v218
    v_cvt_pk_bf16_f32 v221, v219, v219
    v_lshlrev_b32 v219, 16, v221
    v_cvt_pk_bf16_f32 v221, v220, v220
    v_lshlrev_b32 v220, 16, v221
    v_add_f32 v216, v216, v219
    v_add_f32 v217, v217, v220
    v_lshlrev_b32 v218, 16, v211
    v_lshlrev_b32 v219, 16, v201
    v_lshlrev_b32 v220, 16, v206
    v_mul_f32 v219, v219, v218
    v_mul_f32 v220, v220, v218
    v_cvt_pk_bf16_f32 v221, v219, v219
    v_lshlrev_b32 v219, 16, v221
    v_cvt_pk_bf16_f32 v221, v220, v220
    v_lshlrev_b32 v220, 16, v221
    v_add_f32 v216, v216, v219
    v_add_f32 v217, v217, v220
    v_and_b32 v218, 0xffff0000, v211
    v_and_b32 v219, 0xffff0000, v201
    v_and_b32 v220, 0xffff0000, v206
    v_mul_f32 v219, v219, v218
    v_mul_f32 v220, v220, v218
    v_cvt_pk_bf16_f32 v221, v219, v219
    v_lshlrev_b32 v219, 16, v221
    v_cvt_pk_bf16_f32 v221, v220, v220
    v_lshlrev_b32 v220, 16, v221
    v_add_f32 v216, v216, v219
    v_add_f32 v217, v217, v220
    v_lshlrev_b32 v218, 16, v212
    v_lshlrev_b32 v219, 16, v202
    v_lshlrev_b32 v220, 16, v207
    v_mul_f32 v219, v219, v218
    v_mul_f32 v220, v220, v218
    v_cvt_pk_bf16_f32 v221, v219, v219
    v_lshlrev_b32 v219, 16, v221
    v_cvt_pk_bf16_f32 v221, v220, v220
    v_lshlrev_b32 v220, 16, v221
    v_add_f32 v216, v216, v219
    v_add_f32 v217, v217, v220
    v_and_b32 v218, 0xffff0000, v212
    v_and_b32 v219, 0xffff0000, v202
    v_and_b32 v220, 0xffff0000, v207
    v_mul_f32 v219, v219, v218
    v_mul_f32 v220, v220, v218
    v_cvt_pk_bf16_f32 v221, v219, v219
    v_lshlrev_b32 v219, 16, v221
    v_cvt_pk_bf16_f32 v221, v220, v220
    v_lshlrev_b32 v220, 16, v221
    v_add_f32 v216, v216, v219
    v_add_f32 v217, v217, v220
    v_lshlrev_b32 v218, 16, v213
    v_lshlrev_b32 v219, 16, v203
    v_lshlrev_b32 v220, 16, v208
    v_mul_f32 v219, v219, v218
    v_mul_f32 v220, v220, v218
    v_cvt_pk_bf16_f32 v221, v219, v219
    v_lshlrev_b32 v219, 16, v221
    v_cvt_pk_bf16_f32 v221, v220, v220
    v_lshlrev_b32 v220, 16, v221
    v_add_f32 v216, v216, v219
    v_add_f32 v217, v217, v220
    v_and_b32 v218, 0xffff0000, v213
    v_and_b32 v219, 0xffff0000, v203
    v_and_b32 v220, 0xffff0000, v208
    v_mul_f32 v219, v219, v218
    v_mul_f32 v220, v220, v218
    v_cvt_pk_bf16_f32 v221, v219, v219
    v_lshlrev_b32 v219, 16, v221
    v_cvt_pk_bf16_f32 v221, v220, v220
    v_lshlrev_b32 v220, 16, v221
    v_add_f32 v216, v216, v219
    v_add_f32 v217, v217, v220
    v_lshlrev_b32 v218, 16, v214
    v_lshlrev_b32 v219, 16, v204
    v_lshlrev_b32 v220, 16, v209
    v_mul_f32 v219, v219, v218
    v_mul_f32 v220, v220, v218
    v_cvt_pk_bf16_f32 v221, v219, v219
    v_lshlrev_b32 v219, 16, v221
    v_cvt_pk_bf16_f32 v221, v220, v220
    v_lshlrev_b32 v220, 16, v221
    v_add_f32 v216, v216, v219
    v_add_f32 v217, v217, v220
    v_and_b32 v218, 0xffff0000, v214
    v_and_b32 v219, 0xffff0000, v204
    v_and_b32 v220, 0xffff0000, v209
    v_mul_f32 v219, v219, v218
    v_mul_f32 v220, v220, v218
    v_cvt_pk_bf16_f32 v221, v219, v219
    v_lshlrev_b32 v219, 16, v221
    v_cvt_pk_bf16_f32 v221, v220, v220
    v_lshlrev_b32 v220, 16, v221
    v_add_f32 v216, v216, v219
    v_add_f32 v217, v217, v220
    s_nop 1
    v_add_f32_dpp v216, v216, v216 row_ror:8 row_mask:0xf bank_mask:0xf
    v_add_f32_dpp v217, v217, v217 row_ror:8 row_mask:0xf bank_mask:0xf
    s_nop 1
    v_add_f32_dpp v216, v216, v216 row_ror:4 row_mask:0xf bank_mask:0xf
    v_add_f32_dpp v217, v217, v217 row_ror:4 row_mask:0xf bank_mask:0xf
    s_nop 1
    v_add_f32_dpp v216, v216, v216 row_ror:2 row_mask:0xf bank_mask:0xf
    v_add_f32_dpp v217, v217, v217 row_ror:2 row_mask:0xf bank_mask:0xf
    s_nop 1
    v_add_f32_dpp v216, v216, v216 row_ror:1 row_mask:0xf bank_mask:0xf
    v_add_f32_dpp v217, v217, v217 row_ror:1 row_mask:0xf bank_mask:0xf
    s_nop 1
    v_mov_b32 v218, v216
    v_mov_b32 v219, v217
    s_nop 1
    v_permlane16_swap_b32 v216, v218
    v_permlane16_swap_b32 v217, v219
    s_nop 1
    v_add_f32 v216, v216, v218
    v_add_f32 v217, v217, v219
    v_mov_b32 v218, v216
    v_mov_b32 v219, v217
    s_nop 1
    v_permlane32_swap_b32 v216, v218
    v_permlane32_swap_b32 v217, v219
    s_nop 1
    v_add_f32 v216, v216, v218
    v_add_f32 v217, v217, v219
    v_cvt_pk_bf16_f32 v218, v216, v216
    v_lshlrev_b32 v216, 16, v218
    v_cvt_pk_bf16_f32 v218, v217, v217
    v_lshlrev_b32 v217, 16, v218
    v_mul_f32 v218, s13, v216
    v_exp_f32 v218, -v218
    s_nop 0
    v_add_f32 v218, 1.0, v218
    v_rcp_f32 v216, v218
    s_nop 0
    v_cvt_pk_bf16_f32 v218, v216, v216
    v_lshlrev_b32 v216, 16, v218
    v_mul_f32 v218, s13, v217
    v_exp_f32 v218, -v218
    s_nop 0
    v_add_f32 v218, 1.0, v218
    v_rcp_f32 v217, v218
    s_nop 0
    v_cvt_pk_bf16_f32 v218, v217, v217
    v_lshlrev_b32 v217, 16, v218
    v_mov_b32 v110, v216
    v_mov_b32 v111, v217
L_mlp:
    s_waitcnt vmcnt(0)
    s_cmp_lt_u32 s2, 202
    s_cbranch_scc1 L_b1
    v_mov_b32 v112, 0
    v_mov_b32 v113, 0
    v_mov_b32 v114, 0
    v_mov_b32 v115, 0
    v_mov_b32 v116, 0
    v_mov_b32 v117, 0
    v_mov_b32 v118, 0
    v_mov_b32 v119, 0
    v_mov_b32 v120, 0
    v_mov_b32 v121, 0
    v_mov_b32 v122, 0
    v_mov_b32 v123, 0
    v_mov_b32 v124, 0
    v_mov_b32 v125, 0
    v_mov_b32 v126, 0
    v_mov_b32 v127, 0
    v_lshlrev_b32 v100, 16, v100
    v_lshlrev_b32 v101, 16, v101
    v_lshlrev_b32 v102, 16, v102
    v_lshlrev_b32 v103, 16, v103
    v_lshlrev_b32 v104, 16, v104
    v_lshlrev_b32 v105, 16, v105
    v_lshlrev_b32 v106, 16, v106
    v_lshlrev_b32 v107, 16, v107
    v_lshlrev_b32 v108, 16, v108
    v_lshlrev_b32 v109, 16, v109
    v_lshlrev_b32 v24, 16, v80
    v_and_b32 v25, 0xffff0000, v80
    v_fmac_f32 v112, v100, v24
    v_fmac_f32 v113, v100, v25
    v_fmac_f32 v120, v105, v24
    v_fmac_f32 v121, v105, v25
    v_lshlrev_b32 v24, 16, v81
    v_and_b32 v25, 0xffff0000, v81
    v_fmac_f32 v114, v100, v24
    v_fmac_f32 v115, v100, v25
    v_fmac_f32 v122, v105, v24
    v_fmac_f32 v123, v105, v25
    v_lshlrev_b32 v24, 16, v82
    v_and_b32 v25, 0xffff0000, v82
    v_fmac_f32 v116, v100, v24
    v_fmac_f32 v117, v100, v25
    v_fmac_f32 v124, v105, v24
    v_fmac_f32 v125, v105, v25
    v_lshlrev_b32 v24, 16, v83
    v_and_b32 v25, 0xffff0000, v83
    v_fmac_f32 v118, v100, v24
    v_fmac_f32 v119, v100, v25
    v_fmac_f32 v126, v105, v24
    v_fmac_f32 v127, v105, v25
    v_lshlrev_b32 v24, 16, v84
    v_and_b32 v25, 0xffff0000, v84
    v_fmac_f32 v112, v101, v24
    v_fmac_f32 v113, v101, v25
    v_fmac_f32 v120, v106, v24
    v_fmac_f32 v121, v106, v25
    v_lshlrev_b32 v24, 16, v85
    v_and_b32 v25, 0xffff0000, v85
    v_fmac_f32 v114, v101, v24
    v_fmac_f32 v115, v101, v25
    v_fmac_f32 v122, v106, v24
    v_fmac_f32 v123, v106, v25
    v_lshlrev_b32 v24, 16, v86
    v_and_b32 v25, 0xffff0000, v86
    v_fmac_f32 v116, v101, v24
    v_fmac_f32 v117, v101, v25
    v_fmac_f32 v124, v106, v24
    v_fmac_f32 v125, v106, v25
    v_lshlrev_b32 v24, 16, v87
    v_and_b32 v25, 0xffff0000, v87
    v_fmac_f32 v118, v101, v24
    v_fmac_f32 v119, v101, v25
    v_fmac_f32 v126, v106, v24
    v_fmac_f32 v127, v106, v25
    v_lshlrev_b32 v24, 16, v88
    v_and_b32 v25, 0xffff0000, v88
    v_fmac_f32 v112, v102, v24
    v_fmac_f32 v113, v102, v25
    v_fmac_f32 v120, v107, v24
    v_fmac_f32 v121, v107, v25
    v_lshlrev_b32 v24, 16, v89
    v_and_b32 v25, 0xffff0000, v89
    v_fmac_f32 v114, v102, v24
    v_fmac_f32 v115, v102, v25
    v_fmac_f32 v122, v107, v24
    v_fmac_f32 v123, v107, v25
    v_lshlrev_b32 v24, 16, v90
    v_and_b32 v25, 0xffff0000, v90
    v_fmac_f32 v116, v102, v24
    v_fmac_f32 v117, v102, v25
    v_fmac_f32 v124, v107, v24
    v_fmac_f32 v125, v107, v25
    v_lshlrev_b32 v24, 16, v91
    v_and_b32 v25, 0xffff0000, v91
    v_fmac_f32 v118, v102, v24
    v_fmac_f32 v119, v102, v25
    v_fmac_f32 v126, v107, v24
    v_fmac_f32 v127, v107, v25
    v_lshlrev_b32 v24, 16, v92
    v_and_b32 v25, 0xffff0000, v92
    v_fmac_f32 v112, v103, v24
    v_fmac_f32 v113, v103, v25
    v_fmac_f32 v120, v108, v24
    v_fmac_f32 v121, v108, v25
    v_lshlrev_b32 v24, 16, v93
    v_and_b32 v25, 0xffff0000, v93
    v_fmac_f32 v114, v103, v24
    v_fmac_f32 v115, v103, v25
    v_fmac_f32 v122, v108, v24
    v_fmac_f32 v123, v108, v25
    v_lshlrev_b32 v24, 16, v94
    v_and_b32 v25, 0xffff0000, v94
    v_fmac_f32 v116, v103, v24
    v_fmac_f32 v117, v103, v25
    v_fmac_f32 v124, v108, v24
    v_fmac_f32 v125, v108, v25
    v_lshlrev_b32 v24, 16, v95
    v_and_b32 v25, 0xffff0000, v95
    v_fmac_f32 v118, v103, v24
    v_fmac_f32 v119, v103, v25
    v_fmac_f32 v126, v108, v24
    v_fmac_f32 v127, v108, v25
    v_lshlrev_b32 v24, 16, v96
    v_and_b32 v25, 0xffff0000, v96
    v_fmac_f32 v112, v104, v24
    v_fmac_f32 v113, v104, v25
    v_fmac_f32 v120, v109, v24
    v_fmac_f32 v121, v109, v25
    v_lshlrev_b32 v24, 16, v97
    v_and_b32 v25, 0xffff0000, v97
    v_fmac_f32 v114, v104, v24
    v_fmac_f32 v115, v104, v25
    v_fmac_f32 v122, v109, v24
    v_fmac_f32 v123, v109, v25
    v_lshlrev_b32 v24, 16, v98
    v_and_b32 v25, 0xffff0000, v98
    v_fmac_f32 v116, v104, v24
    v_fmac_f32 v117, v104, v25
    v_fmac_f32 v124, v109, v24
    v_fmac_f32 v125, v109, v25
    v_lshlrev_b32 v24, 16, v99
    v_and_b32 v25, 0xffff0000, v99
    v_fmac_f32 v118, v104, v24
    v_fmac_f32 v119, v104, v25
    v_fmac_f32 v126, v109, v24
    v_fmac_f32 v127, v109, v25
    s_nop 1
    v_add_f32_dpp v112, v112, v112 row_ror:4 row_mask:0xf bank_mask:0xf
    v_add_f32_dpp v113, v113, v113 row_ror:4 row_mask:0xf bank_mask:0xf
    v_add_f32_dpp v114, v114, v114 row_ror:4 row_mask:0xf bank_mask:0xf
    v_add_f32_dpp v115, v115, v115 row_ror:4 row_mask:0xf bank_mask:0xf
    v_add_f32_dpp v116, v116, v116 row_ror:4 row_mask:0xf bank_mask:0xf
    v_add_f32_dpp v117, v117, v117 row_ror:4 row_mask:0xf bank_mask:0xf
    v_add_f32_dpp v118, v118, v118 row_ror:4 row_mask:0xf bank_mask:0xf
    v_add_f32_dpp v119, v119, v119 row_ror:4 row_mask:0xf bank_mask:0xf
    v_add_f32_dpp v120, v120, v120 row_ror:4 row_mask:0xf bank_mask:0xf
    v_add_f32_dpp v121, v121, v121 row_ror:4 row_mask:0xf bank_mask:0xf
    v_add_f32_dpp v122, v122, v122 row_ror:4 row_mask:0xf bank_mask:0xf
    v_add_f32_dpp v123, v123, v123 row_ror:4 row_mask:0xf bank_mask:0xf
    v_add_f32_dpp v124, v124, v124 row_ror:4 row_mask:0xf bank_mask:0xf
    v_add_f32_dpp v125, v125, v125 row_ror:4 row_mask:0xf bank_mask:0xf
    v_add_f32_dpp v126, v126, v126 row_ror:4 row_mask:0xf bank_mask:0xf
    v_add_f32_dpp v127, v127, v127 row_ror:4 row_mask:0xf bank_mask:0xf
    v_add_f32_dpp v112, v112, v112 row_ror:8 row_mask:0xf bank_mask:0xf
    v_add_f32_dpp v113, v113, v113 row_ror:8 row_mask:0xf bank_mask:0xf
    v_add_f32_dpp v114, v114, v114 row_ror:8 row_mask:0xf bank_mask:0xf
    v_add_f32_dpp v115, v115, v115 row_ror:8 row_mask:0xf bank_mask:0xf
    v_add_f32_dpp v116, v116, v116 row_ror:8 row_mask:0xf bank_mask:0xf
    v_add_f32_dpp v117, v117, v117 row_ror:8 row_mask:0xf bank_mask:0xf
    v_add_f32_dpp v118, v118, v118 row_ror:8 row_mask:0xf bank_mask:0xf
    v_add_f32_dpp v119, v119, v119 row_ror:8 row_mask:0xf bank_mask:0xf
    v_add_f32_dpp v120, v120, v120 row_ror:8 row_mask:0xf bank_mask:0xf
    v_add_f32_dpp v121, v121, v121 row_ror:8 row_mask:0xf bank_mask:0xf
    v_add_f32_dpp v122, v122, v122 row_ror:8 row_mask:0xf bank_mask:0xf
    v_add_f32_dpp v123, v123, v123 row_ror:8 row_mask:0xf bank_mask:0xf
    v_add_f32_dpp v124, v124, v124 row_ror:8 row_mask:0xf bank_mask:0xf
    v_add_f32_dpp v125, v125, v125 row_ror:8 row_mask:0xf bank_mask:0xf
    v_add_f32_dpp v126, v126, v126 row_ror:8 row_mask:0xf bank_mask:0xf
    v_add_f32_dpp v127, v127, v127 row_ror:8 row_mask:0xf bank_mask:0xf
    v_mov_b32 v128, v112
    v_mov_b32 v129, v113
    v_mov_b32 v130, v114
    v_mov_b32 v131, v115
    v_mov_b32 v132, v116
    v_mov_b32 v133, v117
    v_mov_b32 v134, v118
    v_mov_b32 v135, v119
    v_mov_b32 v136, v120
    v_mov_b32 v137, v121
    v_mov_b32 v138, v122
    v_mov_b32 v139, v123
    v_mov_b32 v140, v124
    v_mov_b32 v141, v125
    v_mov_b32 v142, v126
    v_mov_b32 v143, v127
    s_nop 1
    v_permlane16_swap_b32 v112, v128
    v_permlane16_swap_b32 v113, v129
    v_permlane16_swap_b32 v114, v130
    v_permlane16_swap_b32 v115, v131
    v_permlane16_swap_b32 v116, v132
    v_permlane16_swap_b32 v117, v133
    v_permlane16_swap_b32 v118, v134
    v_permlane16_swap_b32 v119, v135
    v_permlane16_swap_b32 v120, v136
    v_permlane16_swap_b32 v121, v137
    v_permlane16_swap_b32 v122, v138
    v_permlane16_swap_b32 v123, v139
    v_permlane16_swap_b32 v124, v140
    v_permlane16_swap_b32 v125, v141
    v_permlane16_swap_b32 v126, v142
    v_permlane16_swap_b32 v127, v143
    s_nop 1
    v_add_f32 v112, v112, v128
    v_add_f32 v113, v113, v129
    v_add_f32 v114, v114, v130
    v_add_f32 v115, v115, v131
    v_add_f32 v116, v116, v132
    v_add_f32 v117, v117, v133
    v_add_f32 v118, v118, v134
    v_add_f32 v119, v119, v135
    v_add_f32 v120, v120, v136
    v_add_f32 v121, v121, v137
    v_add_f32 v122, v122, v138
    v_add_f32 v123, v123, v139
    v_add_f32 v124, v124, v140
    v_add_f32 v125, v125, v141
    v_add_f32 v126, v126, v142
    v_add_f32 v127, v127, v143
    v_mov_b32 v128, v112
    v_mov_b32 v129, v113
    v_mov_b32 v130, v114
    v_mov_b32 v131, v115
    v_mov_b32 v132, v116
    v_mov_b32 v133, v117
    v_mov_b32 v134, v118
    v_mov_b32 v135, v119
    v_mov_b32 v136, v120
    v_mov_b32 v137, v121
    v_mov_b32 v138, v122
    v_mov_b32 v139, v123
    v_mov_b32 v140, v124
    v_mov_b32 v141, v125
    v_mov_b32 v142, v126
    v_mov_b32 v143, v127
    s_nop 1
    v_permlane32_swap_b32 v112, v128
    v_permlane32_swap_b32 v113, v129
    v_permlane32_swap_b32 v114, v130
    v_permlane32_swap_b32 v115, v131
    v_permlane32_swap_b32 v116, v132
    v_permlane32_swap_b32 v117, v133
    v_permlane32_swap_b32 v118, v134
    v_permlane32_swap_b32 v119, v135
    v_permlane32_swap_b32 v120, v136
    v_permlane32_swap_b32 v121, v137
    v_permlane32_swap_b32 v122, v138
    v_permlane32_swap_b32 v123, v139
    v_permlane32_swap_b32 v124, v140
    v_permlane32_swap_b32 v125, v141
    v_permlane32_swap_b32 v126, v142
    v_permlane32_swap_b32 v127, v143
    s_nop 1
    v_add_f32 v112, v112, v128
    v_add_f32 v113, v113, v129
    v_add_f32 v114, v114, v130
    v_add_f32 v115, v115, v131
    v_add_f32 v116, v116, v132
    v_add_f32 v117, v117, v133
    v_add_f32 v118, v118, v134
    v_add_f32 v119, v119, v135
    v_add_f32 v120, v120, v136
    v_add_f32 v121, v121, v137
    v_add_f32 v122, v122, v138
    v_add_f32 v123, v123, v139
    v_add_f32 v124, v124, v140
    v_add_f32 v125, v125, v141
    v_add_f32 v126, v126, v142
    v_add_f32 v127, v127, v143
    v_and_b32 v21, 3, v1
    s_lshl_b32 s10, s8, 8
    v_lshlrev_b32 v24, 6, v21
    v_add_u32 v24, s10, v24
    ds_write_b128 v24, v[112:115] offset:12288
    ds_write_b128 v24, v[116:119] offset:12304
    ds_write_b128 v24, v[120:123] offset:12320
    ds_write_b128 v24, v[124:127] offset:12336
    s_waitcnt lgkmcnt(0)
    s_barrier
    s_cmp_lg_u32 s8, 2
    s_cbranch_scc1 L_b1
    v_lshrrev_b32 v20, 5, v1
    v_and_b32 v21, 31, v1
    v_lshrrev_b32 v22, 3, v21
    v_lshlrev_b32 v22, 6, v22
    v_lshl_add_u32 v22, v20, 5, v22
    v_and_b32 v23, 7, v21
    v_lshl_add_u32 v22, v23, 2, v22
    ds_read_b32 v112, v22 offset:12288
    ds_read_b32 v113, v22 offset:12544
    ds_read_b32 v114, v22 offset:12800
    ds_read_b32 v115, v22 offset:13056
    ds_read_b32 v116, v22 offset:13312
    ds_read_b32 v117, v22 offset:13568
    ds_read_b32 v118, v22 offset:13824
    ds_read_b32 v119, v22 offset:14080
    s_waitcnt lgkmcnt(0)
    v_add_f32 v112, v112, v113
    v_add_f32 v112, v112, v114
    v_add_f32 v112, v112, v115
    v_add_f32 v112, v112, v116
    v_add_f32 v112, v112, v117
    v_add_f32 v112, v112, v118
    v_add_f32 v112, v112, v119
    v_cvt_pk_bf16_f32 v113, v112, v112
    v_lshlrev_b32 v112, 16, v113
    v_mul_f32 v113, s13, v112
    v_exp_f32 v113, -v113
    s_nop 0
    v_add_f32 v113, 1.0, v113
    v_rcp_f32 v113, v113
    s_nop 0
    v_mul_f32 v112, v112, v113
    v_cvt_pk_bf16_f32 v113, v112, v112
    v_lshlrev_b32 v112, 16, v113
    s_movk_i32 s10, 1728*8
    v_mul_lo_u32 v22, v20, s10
    v_lshl_add_u32 v22, v21, 3, v22
    s_sub_u32 s11, s2, 202
    s_lshl_b32 s11, s11, 8
    s_add_u32 s11, s11, 1572864
    v_mov_b32 v113, s101
    buffer_store_dwordx2 v[112:113], v22, s[56:59], s11 offen sc1
L_b1:
    s_cmp_ge_u32 s2, 250
    s_cbranch_scc1 L_end
    v_lshlrev_b32 v5, 2, v0
    s_cmp_ge_u32 s8, 4
    s_cbranch_scc1 L_s2
    s_cmp_ge_u32 s2, 160
    s_cbranch_scc1 L_s1h
    v_lshrrev_b32 v6, 7, v0
    v_and_b32 v7, 127, v0
    v_lshlrev_b32 v7, 3, v7
    v_lshl_add_u32 v7, v6, 13, v7
    v_lshlrev_b32 v6, 13, v6
    s_mov_b32 s15, 0
L_p1:
    s_lshl_b32 s10, s80, 14
    s_add_u32 s10, s10, 1048576
    buffer_load_dwordx2 v[112:113], v7, s[56:59], s10 offen offset:0 sc1
    buffer_load_dwordx4 v[128:131], v6, s[56:59], s10 offen offset:1024 sc1
    s_add_u32 s10, s10, 2048
    buffer_load_dwordx2 v[114:115], v7, s[56:59], s10 offen offset:0 sc1
    buffer_load_dwordx4 v[132:135], v6, s[56:59], s10 offen offset:1024 sc1
    s_add_u32 s10, s10, 2048
    buffer_load_dwordx2 v[116:117], v7, s[56:59], s10 offen offset:0 sc1
    buffer_load_dwordx4 v[136:139], v6, s[56:59], s10 offen offset:1024 sc1
    s_add_u32 s10, s10, 2048
    buffer_load_dwordx2 v[118:119], v7, s[56:59], s10 offen offset:0 sc1
    buffer_load_dwordx4 v[140:143], v6, s[56:59], s10 offen offset:1024 sc1
    s_add_u32 s10, s10, 2048
    s_add_u32 s10, s10, 253952
    buffer_load_dwordx2 v[120:121], v7, s[56:59], s10 offen offset:0 sc1
    buffer_load_dwordx4 v[144:147], v6, s[56:59], s10 offen offset:1024 sc1
    s_add_u32 s10, s10, 2048
    buffer_load_dwordx2 v[122:123], v7, s[56:59], s10 offen offset:0 sc1
    buffer_load_dwordx4 v[148:151], v6, s[56:59], s10 offen offset:1024 sc1
    s_add_u32 s10, s10, 2048
    buffer_load_dwordx2 v[124:125], v7, s[56:59], s10 offen offset:0 sc1
    buffer_load_dwordx4 v[152:155], v6, s[56:59], s10 offen offset:1024 sc1
    s_add_u32 s10, s10, 2048
    buffer_load_dwordx2 v[126:127], v7, s[56:59], s10 offen offset:0 sc1
    buffer_load_dwordx4 v[156:159], v6, s[56:59], s10 offen offset:1024 sc1
    s_add_u32 s10, s10, 2048
    s_waitcnt vmcnt(0)
    v_xor_b32 v20, s101, v113
    v_xor_b32 v21, s101, v115
    v_or_b32 v20, v20, v21
    v_xor_b32 v21, s101, v117
    v_or_b32 v20, v20, v21
    v_xor_b32 v21, s101, v119
    v_or_b32 v20, v20, v21
    v_xor_b32 v21, s101, v121
    v_or_b32 v20, v20, v21
    v_xor_b32 v21, s101, v123
    v_or_b32 v20, v20, v21
    v_xor_b32 v21, s101, v125
    v_or_b32 v20, v20, v21
    v_xor_b32 v21, s101, v127
    v_or_b32 v20, v20, v21
    v_xor_b32 v21, s101, v129
    v_or_b32 v20, v20, v21
    v_xor_b32 v21, s101, v131
    v_or_b32 v20, v20, v21
    v_xor_b32 v21, s101, v133
    v_or_b32 v20, v20, v21
    v_xor_b32 v21, s101, v135
    v_or_b32 v20, v20, v21
    v_xor_b32 v21, s101, v137
    v_or_b32 v20, v20, v21
    v_xor_b32 v21, s101, v139
    v_or_b32 v20, v20, v21
    v_xor_b32 v21, s101, v141
    v_or_b32 v20, v20, v21
    v_xor_b32 v21, s101, v143
    v_or_b32 v20, v20, v21
    v_xor_b32 v21, s101, v145
    v_or_b32 v20, v20, v21
    v_xor_b32 v21, s101, v147
    v_or_b32 v20, v20, v21
    v_xor_b32 v21, s101, v149
    v_or_b32 v20, v20, v21
    v_xor_b32 v21, s101, v151
    v_or_b32 v20, v20, v21
    v_xor_b32 v21, s101, v153
    v_or_b32 v20, v20, v21
    v_xor_b32 v21, s101, v155
    v_or_b32 v20, v20, v21
    v_xor_b32 v21, s101, v157
    v_or_b32 v20, v20, v21
    v_xor_b32 v21, s101, v159
    v_or_b32 v20, v20, v21
    v_cmp_ne_u32 vcc, 0, v20
    s_nop 4
    s_cbranch_vccz L_p1d
    s_sleep 2
    s_add_u32 s15, s15, 1
    s_cmp_lt_u32 s15, 100000
    s_cbranch_scc1 L_p1
L_p1d:
    v_mov_b32 v32, v112
    v_mov_b32 v40, v128
    v_mov_b32 v41, v130
    v_mov_b32 v33, v114
    v_mov_b32 v42, v132
    v_mov_b32 v43, v134
    v_mov_b32 v34, v116
    v_mov_b32 v44, v136
    v_mov_b32 v45, v138
    v_mov_b32 v35, v118
    v_mov_b32 v46, v140
    v_mov_b32 v47, v142
    v_mov_b32 v36, v120
    v_mov_b32 v48, v144
    v_mov_b32 v49, v146
    v_mov_b32 v37, v122
    v_mov_b32 v50, v148
    v_mov_b32 v51, v150
    v_mov_b32 v38, v124
    v_mov_b32 v52, v152
    v_mov_b32 v53, v154
    v_mov_b32 v39, v126
    v_mov_b32 v54, v156
    v_mov_b32 v55, v158
    v_max3_f32 v20, v40, v42, v44
    v_max_f32 v20, v20, v46
    v_mul_f32 v20, s13, v20
    v_fma_f32 v40, v40, s13, -v20
    v_fma_f32 v42, v42, s13, -v20
    v_fma_f32 v44, v44, s13, -v20
    v_fma_f32 v46, v46, s13, -v20
    v_exp_f32 v40, v40
    v_exp_f32 v42, v42
    v_exp_f32 v44, v44
    v_exp_f32 v46, v46
    s_nop 0
    v_mul_f32 v21, v40, v41
    v_fmac_f32 v21, v42, v43
    v_fmac_f32 v21, v44, v45
    v_fmac_f32 v21, v46, v47
    v_rcp_f32 v21, v21
    v_mul_f32 v32, v40, v32
    v_fmac_f32 v32, v42, v33
    v_fmac_f32 v32, v44, v34
    v_fmac_f32 v32, v46, v35
    v_mul_f32 v32, v32, v21
    v_cvt_pk_bf16_f32 v22, v32, v32
    v_lshlrev_b32 v32, 16, v22
    v_max3_f32 v20, v48, v50, v52
    v_max_f32 v20, v20, v54
    v_mul_f32 v20, s13, v20
    v_fma_f32 v48, v48, s13, -v20
    v_fma_f32 v50, v50, s13, -v20
    v_fma_f32 v52, v52, s13, -v20
    v_fma_f32 v54, v54, s13, -v20
    v_exp_f32 v48, v48
    v_exp_f32 v50, v50
    v_exp_f32 v52, v52
    v_exp_f32 v54, v54
    s_nop 0
    v_mul_f32 v21, v48, v49
    v_fmac_f32 v21, v50, v51
    v_fmac_f32 v21, v52, v53
    v_fmac_f32 v21, v54, v55
    v_rcp_f32 v21, v21
    v_mul_f32 v36, v48, v36
    v_fmac_f32 v36, v50, v37
    v_fmac_f32 v36, v52, v38
    v_fmac_f32 v36, v54, v39
    v_mul_f32 v36, v36, v21
    v_cvt_pk_bf16_f32 v22, v36, v36
    v_lshlrev_b32 v36, 16, v22
    ds_write_b32 v5, v32 offset:16384
    ds_write_b32 v5, v36 offset:17408
    s_branch L_s2
L_s1h:
    v_min_u32 v6, 191, v0
    v_lshlrev_b32 v6, 3, v6
    s_mov_b32 s15, 0
L_p2:
    s_lshl_b32 s10, s82, 3
    s_add_u32 s10, s10, 1572864
    buffer_load_dwordx2 v[112:113], v6, s[56:59], s10 offen sc1
    s_add_u32 s10, s10, 13824
    buffer_load_dwordx2 v[114:115], v6, s[56:59], s10 offen sc1
    s_waitcnt vmcnt(0)
    v_xor_b32 v20, s101, v113
    v_xor_b32 v21, s101, v115
    v_or_b32 v20, v20, v21
    v_cmp_ne_u32 vcc, 0, v20
    s_nop 4
    s_cbranch_vccz L_p2d
    s_sleep 2
    s_add_u32 s15, s15, 1
    s_cmp_lt_u32 s15, 100000
    s_cbranch_scc1 L_p2
L_p2d:
    v_mov_b32 v32, v112
    v_mov_b32 v36, v114
    v_cmp_gt_u32 vcc, 192, v0
    s_nop 1
    v_cndmask_b32 v32, 0, v32, vcc
    v_cndmask_b32 v36, 0, v36, vcc
    ds_write_b32 v5, v32 offset:16384
    ds_write_b32 v5, v36 offset:17408
L_s2:
    s_waitcnt lgkmcnt(0)
    s_barrier
    v_lshrrev_b32 v2, 3, v1
    v_and_b32 v3, 7, v1
    s_lshl_b32 s10, s8, 7
    v_lshlrev_b32 v6, 2, v2
    v_add_u32 v6, s10, v6
    ds_read_b32 v32, v6 offset:16384
    ds_read_b32 v33, v6 offset:17408
    ds_read_b32 v34, v6 offset:16416
    ds_read_b32 v35, v6 offset:17440
    ds_read_b32 v36, v6 offset:16448
    ds_read_b32 v37, v6 offset:17472
    ds_read_b32 v38, v6 offset:16480
    ds_read_b32 v39, v6 offset:17504
    v_mov_b32 v112, 0
    v_mov_b32 v113, 0
    v_mov_b32 v114, 0
    v_mov_b32 v115, 0
    v_mov_b32 v116, 0
    v_mov_b32 v117, 0
    v_mov_b32 v118, 0
    v_mov_b32 v119, 0
    v_mov_b32 v120, 0
    v_mov_b32 v121, 0
    v_mov_b32 v122, 0
    v_mov_b32 v123, 0
    v_mov_b32 v124, 0
    v_mov_b32 v125, 0
    v_mov_b32 v126, 0
    v_mov_b32 v127, 0
    s_waitcnt lgkmcnt(0)
    v_lshlrev_b32 v20, 16, v64
    v_and_b32 v21, 0xffff0000, v64
    v_fmac_f32 v112, v32, v20
    v_fmac_f32 v113, v32, v21
    v_fmac_f32 v120, v33, v20
    v_fmac_f32 v121, v33, v21
    v_lshlrev_b32 v20, 16, v65
    v_and_b32 v21, 0xffff0000, v65
    v_fmac_f32 v114, v32, v20
    v_fmac_f32 v115, v32, v21
    v_fmac_f32 v122, v33, v20
    v_fmac_f32 v123, v33, v21
    v_lshlrev_b32 v20, 16, v66
    v_and_b32 v21, 0xffff0000, v66
    v_fmac_f32 v116, v32, v20
    v_fmac_f32 v117, v32, v21
    v_fmac_f32 v124, v33, v20
    v_fmac_f32 v125, v33, v21
    v_lshlrev_b32 v20, 16, v67
    v_and_b32 v21, 0xffff0000, v67
    v_fmac_f32 v118, v32, v20
    v_fmac_f32 v119, v32, v21
    v_fmac_f32 v126, v33, v20
    v_fmac_f32 v127, v33, v21
    v_lshlrev_b32 v20, 16, v68
    v_and_b32 v21, 0xffff0000, v68
    v_fmac_f32 v112, v34, v20
    v_fmac_f32 v113, v34, v21
    v_fmac_f32 v120, v35, v20
    v_fmac_f32 v121, v35, v21
    v_lshlrev_b32 v20, 16, v69
    v_and_b32 v21, 0xffff0000, v69
    v_fmac_f32 v114, v34, v20
    v_fmac_f32 v115, v34, v21
    v_fmac_f32 v122, v35, v20
    v_fmac_f32 v123, v35, v21
    v_lshlrev_b32 v20, 16, v70
    v_and_b32 v21, 0xffff0000, v70
    v_fmac_f32 v116, v34, v20
    v_fmac_f32 v117, v34, v21
    v_fmac_f32 v124, v35, v20
    v_fmac_f32 v125, v35, v21
    v_lshlrev_b32 v20, 16, v71
    v_and_b32 v21, 0xffff0000, v71
    v_fmac_f32 v118, v34, v20
    v_fmac_f32 v119, v34, v21
    v_fmac_f32 v126, v35, v20
    v_fmac_f32 v127, v35, v21
    v_lshlrev_b32 v20, 16, v72
    v_and_b32 v21, 0xffff0000, v72
    v_fmac_f32 v112, v36, v20
    v_fmac_f32 v113, v36, v21
    v_fmac_f32 v120, v37, v20
    v_fmac_f32 v121, v37, v21
    v_lshlrev_b32 v20, 16, v73
    v_and_b32 v21, 0xffff0000, v73
    v_fmac_f32 v114, v36, v20
    v_fmac_f32 v115, v36, v21
    v_fmac_f32 v122, v37, v20
    v_fmac_f32 v123, v37, v21
    v_lshlrev_b32 v20, 16, v74
    v_and_b32 v21, 0xffff0000, v74
    v_fmac_f32 v116, v36, v20
    v_fmac_f32 v117, v36, v21
    v_fmac_f32 v124, v37, v20
    v_fmac_f32 v125, v37, v21
    v_lshlrev_b32 v20, 16, v75
    v_and_b32 v21, 0xffff0000, v75
    v_fmac_f32 v118, v36, v20
    v_fmac_f32 v119, v36, v21
    v_fmac_f32 v126, v37, v20
    v_fmac_f32 v127, v37, v21
    v_lshlrev_b32 v20, 16, v76
    v_and_b32 v21, 0xffff0000, v76
    v_fmac_f32 v112, v38, v20
    v_fmac_f32 v113, v38, v21
    v_fmac_f32 v120, v39, v20
    v_fmac_f32 v121, v39, v21
    v_lshlrev_b32 v20, 16, v77
    v_and_b32 v21, 0xffff0000, v77
    v_fmac_f32 v114, v38, v20
    v_fmac_f32 v115, v38, v21
    v_fmac_f32 v122, v39, v20
    v_fmac_f32 v123, v39, v21
    v_lshlrev_b32 v20, 16, v78
    v_and_b32 v21, 0xffff0000, v78
    v_fmac_f32 v116, v38, v20
    v_fmac_f32 v117, v38, v21
    v_fmac_f32 v124, v39, v20
    v_fmac_f32 v125, v39, v21
    v_lshlrev_b32 v20, 16, v79
    v_and_b32 v21, 0xffff0000, v79
    v_fmac_f32 v118, v38, v20
    v_fmac_f32 v119, v38, v21
    v_fmac_f32 v126, v39, v20
    v_fmac_f32 v127, v39, v21
    s_nop 1
    v_add_f32_dpp v112, v112, v112 row_ror:8 row_mask:0xf bank_mask:0xf
    v_add_f32_dpp v113, v113, v113 row_ror:8 row_mask:0xf bank_mask:0xf
    v_add_f32_dpp v114, v114, v114 row_ror:8 row_mask:0xf bank_mask:0xf
    v_add_f32_dpp v115, v115, v115 row_ror:8 row_mask:0xf bank_mask:0xf
    v_add_f32_dpp v116, v116, v116 row_ror:8 row_mask:0xf bank_mask:0xf
    v_add_f32_dpp v117, v117, v117 row_ror:8 row_mask:0xf bank_mask:0xf
    v_add_f32_dpp v118, v118, v118 row_ror:8 row_mask:0xf bank_mask:0xf
    v_add_f32_dpp v119, v119, v119 row_ror:8 row_mask:0xf bank_mask:0xf
    v_add_f32_dpp v120, v120, v120 row_ror:8 row_mask:0xf bank_mask:0xf
    v_add_f32_dpp v121, v121, v121 row_ror:8 row_mask:0xf bank_mask:0xf
    v_add_f32_dpp v122, v122, v122 row_ror:8 row_mask:0xf bank_mask:0xf
    v_add_f32_dpp v123, v123, v123 row_ror:8 row_mask:0xf bank_mask:0xf
    v_add_f32_dpp v124, v124, v124 row_ror:8 row_mask:0xf bank_mask:0xf
    v_add_f32_dpp v125, v125, v125 row_ror:8 row_mask:0xf bank_mask:0xf
    v_add_f32_dpp v126, v126, v126 row_ror:8 row_mask:0xf bank_mask:0xf
    v_add_f32_dpp v127, v127, v127 row_ror:8 row_mask:0xf bank_mask:0xf
    v_mov_b32 v128, v112
    v_mov_b32 v129, v113
    v_mov_b32 v130, v114
    v_mov_b32 v131, v115
    v_mov_b32 v132, v116
    v_mov_b32 v133, v117
    v_mov_b32 v134, v118
    v_mov_b32 v135, v119
    v_mov_b32 v136, v120
    v_mov_b32 v137, v121
    v_mov_b32 v138, v122
    v_mov_b32 v139, v123
    v_mov_b32 v140, v124
    v_mov_b32 v141, v125
    v_mov_b32 v142, v126
    v_mov_b32 v143, v127
    s_nop 1
    v_permlane16_swap_b32 v112, v128
    v_permlane16_swap_b32 v113, v129
    v_permlane16_swap_b32 v114, v130
    v_permlane16_swap_b32 v115, v131
    v_permlane16_swap_b32 v116, v132
    v_permlane16_swap_b32 v117, v133
    v_permlane16_swap_b32 v118, v134
    v_permlane16_swap_b32 v119, v135
    v_permlane16_swap_b32 v120, v136
    v_permlane16_swap_b32 v121, v137
    v_permlane16_swap_b32 v122, v138
    v_permlane16_swap_b32 v123, v139
    v_permlane16_swap_b32 v124, v140
    v_permlane16_swap_b32 v125, v141
    v_permlane16_swap_b32 v126, v142
    v_permlane16_swap_b32 v127, v143
    s_nop 1
    v_add_f32 v112, v112, v128
    v_add_f32 v113, v113, v129
    v_add_f32 v114, v114, v130
    v_add_f32 v115, v115, v131
    v_add_f32 v116, v116, v132
    v_add_f32 v117, v117, v133
    v_add_f32 v118, v118, v134
    v_add_f32 v119, v119, v135
    v_add_f32 v120, v120, v136
    v_add_f32 v121, v121, v137
    v_add_f32 v122, v122, v138
    v_add_f32 v123, v123, v139
    v_add_f32 v124, v124, v140
    v_add_f32 v125, v125, v141
    v_add_f32 v126, v126, v142
    v_add_f32 v127, v127, v143
    v_mov_b32 v128, v112
    v_mov_b32 v129, v113
    v_mov_b32 v130, v114
    v_mov_b32 v131, v115
    v_mov_b32 v132, v116
    v_mov_b32 v133, v117
    v_mov_b32 v134, v118
    v_mov_b32 v135, v119
    v_mov_b32 v136, v120
    v_mov_b32 v137, v121
    v_mov_b32 v138, v122
    v_mov_b32 v139, v123
    v_mov_b32 v140, v124
    v_mov_b32 v141, v125
    v_mov_b32 v142, v126
    v_mov_b32 v143, v127
    s_nop 1
    v_permlane32_swap_b32 v112, v128
    v_permlane32_swap_b32 v113, v129
    v_permlane32_swap_b32 v114, v130
    v_permlane32_swap_b32 v115, v131
    v_permlane32_swap_b32 v116, v132
    v_permlane32_swap_b32 v117, v133
    v_permlane32_swap_b32 v118, v134
    v_permlane32_swap_b32 v119, v135
    v_permlane32_swap_b32 v120, v136
    v_permlane32_swap_b32 v121, v137
    v_permlane32_swap_b32 v122, v138
    v_permlane32_swap_b32 v123, v139
    v_permlane32_swap_b32 v124, v140
    v_permlane32_swap_b32 v125, v141
    v_permlane32_swap_b32 v126, v142
    v_permlane32_swap_b32 v127, v143
    s_nop 1
    v_add_f32 v112, v112, v128
    v_add_f32 v113, v113, v129
    v_add_f32 v114, v114, v130
    v_add_f32 v115, v115, v131
    v_add_f32 v116, v116, v132
    v_add_f32 v117, v117, v133
    v_add_f32 v118, v118, v134
    v_add_f32 v119, v119, v135
    v_add_f32 v120, v120, v136
    v_add_f32 v121, v121, v137
    v_add_f32 v122, v122, v138
    v_add_f32 v123, v123, v139
    v_add_f32 v124, v124, v140
    v_add_f32 v125, v125, v141
    v_add_f32 v126, v126, v142
    v_add_f32 v127, v127, v143
    s_lshl_b32 s10, s8, 9
    v_lshlrev_b32 v6, 6, v3
    v_add_u32 v6, s10, v6
    ds_write_b128 v6, v[112:115] offset:18432
    ds_write_b128 v6, v[116:119] offset:18448
    ds_write_b128 v6, v[120:123] offset:18464
    ds_write_b128 v6, v[124:127] offset:18480
    s_waitcnt lgkmcnt(0)
    s_barrier
    s_cmp_lg_u32 s8, 0
    s_cbranch_scc1 L_end
    v_lshlrev_b32 v6, 6, v2
    v_lshl_add_u32 v6, v3, 2, v6
    ds_read_b32 v32, v6 offset:18432
    ds_read_b32 v40, v6 offset:18464
    ds_read_b32 v33, v6 offset:18944
    ds_read_b32 v41, v6 offset:18976
    ds_read_b32 v34, v6 offset:19456
    ds_read_b32 v42, v6 offset:19488
    ds_read_b32 v35, v6 offset:19968
    ds_read_b32 v43, v6 offset:20000
    ds_read_b32 v36, v6 offset:20480
    ds_read_b32 v44, v6 offset:20512
    ds_read_b32 v37, v6 offset:20992
    ds_read_b32 v45, v6 offset:21024
    ds_read_b32 v38, v6 offset:21504
    ds_read_b32 v46, v6 offset:21536
    ds_read_b32 v39, v6 offset:22016
    ds_read_b32 v47, v6 offset:22048
    s_waitcnt lgkmcnt(0)
    v_add_f32 v32, v32, v33
    v_add_f32 v40, v40, v41
    v_add_f32 v32, v32, v34
    v_add_f32 v40, v40, v42
    v_add_f32 v32, v32, v35
    v_add_f32 v40, v40, v43
    v_add_f32 v32, v32, v36
    v_add_f32 v40, v40, v44
    v_add_f32 v32, v32, v37
    v_add_f32 v40, v40, v45
    v_add_f32 v32, v32, v38
    v_add_f32 v40, v40, v46
    v_add_f32 v32, v32, v39
    v_add_f32 v40, v40, v47
    s_mul_i32 s10, s80, 10240
    s_lshl_b32 s11, s81, 9
    s_add_u32 s10, s10, s11
    s_add_u32 s10, s10, 1638400
    v_lshlrev_b32 v6, 3, v1
    v_mov_b32 v33, s101
    v_mov_b32 v41, s101
    buffer_store_dwordx2 v[32:33], v6, s[56:59], s10 offen sc1
    s_add_u32 s10, s10, 5120
    buffer_store_dwordx2 v[40:41], v6, s[56:59], s10 offen sc1
    s_cmp_lg_u32 s80, 24
    s_cbranch_scc1 L_end
    s_mov_b32 s15, 0
L_p3:
    s_lshl_b32 s10, s81, 9
    s_add_u32 s10, s10, 1638400
    buffer_load_dwordx2 v[148:149], v6, s[56:59], s10 offen sc1
    s_add_u32 s10, s10, 5120
    buffer_load_dwordx2 v[150:151], v6, s[56:59], s10 offen sc1
    s_add_u32 s10, s10, 5120
    buffer_load_dwordx2 v[152:153], v6, s[56:59], s10 offen sc1
    s_add_u32 s10, s10, 5120
    buffer_load_dwordx2 v[154:155], v6, s[56:59], s10 offen sc1
    s_add_u32 s10, s10, 5120
    buffer_load_dwordx2 v[156:157], v6, s[56:59], s10 offen sc1
    s_add_u32 s10, s10, 5120
    buffer_load_dwordx2 v[158:159], v6, s[56:59], s10 offen sc1
    s_add_u32 s10, s10, 5120
    buffer_load_dwordx2 v[160:161], v6, s[56:59], s10 offen sc1
    s_add_u32 s10, s10, 5120
    buffer_load_dwordx2 v[162:163], v6, s[56:59], s10 offen sc1
    s_add_u32 s10, s10, 5120
    buffer_load_dwordx2 v[164:165], v6, s[56:59], s10 offen sc1
    s_add_u32 s10, s10, 5120
    buffer_load_dwordx2 v[166:167], v6, s[56:59], s10 offen sc1
    s_add_u32 s10, s10, 5120
    buffer_load_dwordx2 v[168:169], v6, s[56:59], s10 offen sc1
    s_add_u32 s10, s10, 5120
    buffer_load_dwordx2 v[170:171], v6, s[56:59], s10 offen sc1
    s_add_u32 s10, s10, 5120
    buffer_load_dwordx2 v[172:173], v6, s[56:59], s10 offen sc1
    s_add_u32 s10, s10, 5120
    buffer_load_dwordx2 v[174:175], v6, s[56:59], s10 offen sc1
    s_add_u32 s10, s10, 5120
    buffer_load_dwordx2 v[176:177], v6, s[56:59], s10 offen sc1
    s_add_u32 s10, s10, 5120
    buffer_load_dwordx2 v[178:179], v6, s[56:59], s10 offen sc1
    s_add_u32 s10, s10, 5120
    buffer_load_dwordx2 v[180:181], v6, s[56:59], s10 offen sc1
    s_add_u32 s10, s10, 5120
    buffer_load_dwordx2 v[182:183], v6, s[56:59], s10 offen sc1
    s_add_u32 s10, s10, 5120
    buffer_load_dwordx2 v[184:185], v6, s[56:59], s10 offen sc1
    s_add_u32 s10, s10, 5120
    buffer_load_dwordx2 v[186:187], v6, s[56:59], s10 offen sc1
    s_add_u32 s10, s10, 5120
    buffer_load_dwordx2 v[188:189], v6, s[56:59], s10 offen sc1
    s_add_u32 s10, s10, 5120
    buffer_load_dwordx2 v[190:191], v6, s[56:59], s10 offen sc1
    s_add_u32 s10, s10, 5120
    buffer_load_dwordx2 v[192:193], v6, s[56:59], s10 offen sc1
    s_add_u32 s10, s10, 5120
    buffer_load_dwordx2 v[194:195], v6, s[56:59], s10 offen sc1
    s_add_u32 s10, s10, 5120
    buffer_load_dwordx2 v[196:197], v6, s[56:59], s10 offen sc1
    s_add_u32 s10, s10, 5120
    buffer_load_dwordx2 v[198:199], v6, s[56:59], s10 offen sc1
    s_add_u32 s10, s10, 5120
    buffer_load_dwordx2 v[200:201], v6, s[56:59], s10 offen sc1
    s_add_u32 s10, s10, 5120
    buffer_load_dwordx2 v[202:203], v6, s[56:59], s10 offen sc1
    s_add_u32 s10, s10, 5120
    buffer_load_dwordx2 v[204:205], v6, s[56:59], s10 offen sc1
    s_add_u32 s10, s10, 5120
    buffer_load_dwordx2 v[206:207], v6, s[56:59], s10 offen sc1
    s_add_u32 s10, s10, 5120
    buffer_load_dwordx2 v[208:209], v6, s[56:59], s10 offen sc1
    s_add_u32 s10, s10, 5120
    buffer_load_dwordx2 v[210:211], v6, s[56:59], s10 offen sc1
    s_add_u32 s10, s10, 5120
    buffer_load_dwordx2 v[212:213], v6, s[56:59], s10 offen sc1
    s_add_u32 s10, s10, 5120
    buffer_load_dwordx2 v[214:215], v6, s[56:59], s10 offen sc1
    s_add_u32 s10, s10, 5120
    buffer_load_dwordx2 v[216:217], v6, s[56:59], s10 offen sc1
    s_add_u32 s10, s10, 5120
    buffer_load_dwordx2 v[218:219], v6, s[56:59], s10 offen sc1
    s_add_u32 s10, s10, 5120
    buffer_load_dwordx2 v[220:221], v6, s[56:59], s10 offen sc1
    s_add_u32 s10, s10, 5120
    buffer_load_dwordx2 v[222:223], v6, s[56:59], s10 offen sc1
    s_add_u32 s10, s10, 5120
    buffer_load_dwordx2 v[224:225], v6, s[56:59], s10 offen sc1
    s_add_u32 s10, s10, 5120
    buffer_load_dwordx2 v[226:227], v6, s[56:59], s10 offen sc1
    s_add_u32 s10, s10, 5120
    buffer_load_dwordx2 v[228:229], v6, s[56:59], s10 offen sc1
    s_add_u32 s10, s10, 5120
    buffer_load_dwordx2 v[230:231], v6, s[56:59], s10 offen sc1
    s_add_u32 s10, s10, 5120
    buffer_load_dwordx2 v[232:233], v6, s[56:59], s10 offen sc1
    s_add_u32 s10, s10, 5120
    buffer_load_dwordx2 v[234:235], v6, s[56:59], s10 offen sc1
    s_add_u32 s10, s10, 5120
    buffer_load_dwordx2 v[236:237], v6, s[56:59], s10 offen sc1
    s_add_u32 s10, s10, 5120
    buffer_load_dwordx2 v[238:239], v6, s[56:59], s10 offen sc1
    s_add_u32 s10, s10, 5120
    buffer_load_dwordx2 v[240:241], v6, s[56:59], s10 offen sc1
    s_add_u32 s10, s10, 5120
    buffer_load_dwordx2 v[242:243], v6, s[56:59], s10 offen sc1
    s_add_u32 s10, s10, 5120
    buffer_load_dwordx2 v[244:245], v6, s[56:59], s10 offen sc1
    s_add_u32 s10, s10, 5120
    buffer_load_dwordx2 v[246:247], v6, s[56:59], s10 offen sc1
    s_add_u32 s10, s10, 5120
    s_waitcnt vmcnt(0)
    v_mov_b32 v20, 0
    v_xor_b32 v21, s101, v149
    v_or_b32 v20, v20, v21
    v_xor_b32 v21, s101, v151
    v_or_b32 v20, v20, v21
    v_xor_b32 v21, s101, v153
    v_or_b32 v20, v20, v21
    v_xor_b32 v21, s101, v155
    v_or_b32 v20, v20, v21
    v_xor_b32 v21, s101, v157
    v_or_b32 v20, v20, v21
    v_xor_b32 v21, s101, v159
    v_or_b32 v20, v20, v21
    v_xor_b32 v21, s101, v161
    v_or_b32 v20, v20, v21
    v_xor_b32 v21, s101, v163
    v_or_b32 v20, v20, v21
    v_xor_b32 v21, s101, v165
    v_or_b32 v20, v20, v21
    v_xor_b32 v21, s101, v167
    v_or_b32 v20, v20, v21
    v_xor_b32 v21, s101, v169
    v_or_b32 v20, v20, v21
    v_xor_b32 v21, s101, v171
    v_or_b32 v20, v20, v21
    v_xor_b32 v21, s101, v173
    v_or_b32 v20, v20, v21
    v_xor_b32 v21, s101, v175
    v_or_b32 v20, v20, v21
    v_xor_b32 v21, s101, v177
    v_or_b32 v20, v20, v21
    v_xor_b32 v21, s101, v179
    v_or_b32 v20, v20, v21
    v_xor_b32 v21, s101, v181
    v_or_b32 v20, v20, v21
    v_xor_b32 v21, s101, v183
    v_or_b32 v20, v20, v21
    v_xor_b32 v21, s101, v185
    v_or_b32 v20, v20, v21
    v_xor_b32 v21, s101, v187
    v_or_b32 v20, v20, v21
    v_xor_b32 v21, s101, v189
    v_or_b32 v20, v20, v21
    v_xor_b32 v21, s101, v191
    v_or_b32 v20, v20, v21
    v_xor_b32 v21, s101, v193
    v_or_b32 v20, v20, v21
    v_xor_b32 v21, s101, v195
    v_or_b32 v20, v20, v21
    v_xor_b32 v21, s101, v197
    v_or_b32 v20, v20, v21
    v_xor_b32 v21, s101, v199
    v_or_b32 v20, v20, v21
    v_xor_b32 v21, s101, v201
    v_or_b32 v20, v20, v21
    v_xor_b32 v21, s101, v203
    v_or_b32 v20, v20, v21
    v_xor_b32 v21, s101, v205
    v_or_b32 v20, v20, v21
    v_xor_b32 v21, s101, v207
    v_or_b32 v20, v20, v21
    v_xor_b32 v21, s101, v209
    v_or_b32 v20, v20, v21
    v_xor_b32 v21, s101, v211
    v_or_b32 v20, v20, v21
    v_xor_b32 v21, s101, v213
    v_or_b32 v20, v20, v21
    v_xor_b32 v21, s101, v215
    v_or_b32 v20, v20, v21
    v_xor_b32 v21, s101, v217
    v_or_b32 v20, v20, v21
    v_xor_b32 v21, s101, v219
    v_or_b32 v20, v20, v21
    v_xor_b32 v21, s101, v221
    v_or_b32 v20, v20, v21
    v_xor_b32 v21, s101, v223
    v_or_b32 v20, v20, v21
    v_xor_b32 v21, s101, v225
    v_or_b32 v20, v20, v21
    v_xor_b32 v21, s101, v227
    v_or_b32 v20, v20, v21
    v_xor_b32 v21, s101, v229
    v_or_b32 v20, v20, v21
    v_xor_b32 v21, s101, v231
    v_or_b32 v20, v20, v21
    v_xor_b32 v21, s101, v233
    v_or_b32 v20, v20, v21
    v_xor_b32 v21, s101, v235
    v_or_b32 v20, v20, v21
    v_xor_b32 v21, s101, v237
    v_or_b32 v20, v20, v21
    v_xor_b32 v21, s101, v239
    v_or_b32 v20, v20, v21
    v_xor_b32 v21, s101, v241
    v_or_b32 v20, v20, v21
    v_xor_b32 v21, s101, v243
    v_or_b32 v20, v20, v21
    v_xor_b32 v21, s101, v245
    v_or_b32 v20, v20, v21
    v_xor_b32 v21, s101, v247
    v_or_b32 v20, v20, v21
    v_cmp_ne_u32 vcc, 0, v20
    s_nop 4
    s_cbranch_vccz L_p3d
    s_sleep 2
    s_add_u32 s15, s15, 1
    s_cmp_lt_u32 s15, 100000
    s_cbranch_scc1 L_p3
L_p3d:
    v_mov_b32 v40, v148
    v_mov_b32 v72, v150
    v_mov_b32 v41, v152
    v_mov_b32 v73, v154
    v_mov_b32 v42, v156
    v_mov_b32 v74, v158
    v_mov_b32 v43, v160
    v_mov_b32 v75, v162
    v_mov_b32 v44, v164
    v_mov_b32 v76, v166
    v_mov_b32 v45, v168
    v_mov_b32 v77, v170
    v_mov_b32 v46, v172
    v_mov_b32 v78, v174
    v_mov_b32 v47, v176
    v_mov_b32 v79, v178
    v_mov_b32 v48, v180
    v_mov_b32 v80, v182
    v_mov_b32 v49, v184
    v_mov_b32 v81, v186
    v_mov_b32 v50, v188
    v_mov_b32 v82, v190
    v_mov_b32 v51, v192
    v_mov_b32 v83, v194
    v_mov_b32 v52, v196
    v_mov_b32 v84, v198
    v_mov_b32 v53, v200
    v_mov_b32 v85, v202
    v_mov_b32 v54, v204
    v_mov_b32 v86, v206
    v_mov_b32 v55, v208
    v_mov_b32 v87, v210
    v_mov_b32 v56, v212
    v_mov_b32 v88, v214
    v_mov_b32 v57, v216
    v_mov_b32 v89, v218
    v_mov_b32 v58, v220
    v_mov_b32 v90, v222
    v_mov_b32 v59, v224
    v_mov_b32 v91, v226
    v_mov_b32 v60, v228
    v_mov_b32 v92, v230
    v_mov_b32 v61, v232
    v_mov_b32 v93, v234
    v_mov_b32 v62, v236
    v_mov_b32 v94, v238
    v_mov_b32 v63, v240
    v_mov_b32 v95, v242
    v_mov_b32 v64, v244
    v_mov_b32 v96, v246
    v_add_f32 v40, v40, v41
    v_add_f32 v40, v40, v42
    v_add_f32 v40, v40, v43
    v_add_f32 v40, v40, v44
    v_add_f32 v40, v40, v45
    v_add_f32 v40, v40, v46
    v_add_f32 v40, v40, v47
    v_add_f32 v40, v40, v48
    v_add_f32 v40, v40, v49
    v_add_f32 v40, v40, v50
    v_add_f32 v40, v40, v51
    v_add_f32 v40, v40, v52
    v_add_f32 v40, v40, v53
    v_add_f32 v40, v40, v54
    v_add_f32 v40, v40, v55
    v_add_f32 v56, v56, v57
    v_add_f32 v56, v56, v58
    v_add_f32 v56, v56, v59
    v_add_f32 v56, v56, v60
    v_add_f32 v56, v56, v61
    v_add_f32 v56, v56, v62
    v_add_f32 v56, v56, v63
    v_add_f32 v56, v56, v64
    v_cvt_pk_bf16_f32 v22, v40, v40
    v_lshlrev_b32 v40, 16, v22
    v_cvt_pk_bf16_f32 v22, v56, v56
    v_lshlrev_b32 v56, 16, v22
    v_mul_f32 v24, v110, v40
    v_cvt_pk_bf16_f32 v22, v24, v24
    v_lshlrev_b32 v24, 16, v22
    v_sub_f32 v25, 1.0, v110
    v_cvt_pk_bf16_f32 v22, v25, v25
    v_lshlrev_b32 v25, 16, v22
    v_mul_f32 v25, v25, v56
    v_cvt_pk_bf16_f32 v22, v25, v25
    v_lshlrev_b32 v25, 16, v22
    v_add_f32 v24, v24, v25
    v_cvt_pk_bf16_f32 v40, v24, v24
    v_add_f32 v72, v72, v73
    v_add_f32 v72, v72, v74
    v_add_f32 v72, v72, v75
    v_add_f32 v72, v72, v76
    v_add_f32 v72, v72, v77
    v_add_f32 v72, v72, v78
    v_add_f32 v72, v72, v79
    v_add_f32 v72, v72, v80
    v_add_f32 v72, v72, v81
    v_add_f32 v72, v72, v82
    v_add_f32 v72, v72, v83
    v_add_f32 v72, v72, v84
    v_add_f32 v72, v72, v85
    v_add_f32 v72, v72, v86
    v_add_f32 v72, v72, v87
    v_add_f32 v88, v88, v89
    v_add_f32 v88, v88, v90
    v_add_f32 v88, v88, v91
    v_add_f32 v88, v88, v92
    v_add_f32 v88, v88, v93
    v_add_f32 v88, v88, v94
    v_add_f32 v88, v88, v95
    v_add_f32 v88, v88, v96
    v_cvt_pk_bf16_f32 v22, v72, v72
    v_lshlrev_b32 v72, 16, v22
    v_cvt_pk_bf16_f32 v22, v88, v88
    v_lshlrev_b32 v88, 16, v22
    v_mul_f32 v24, v111, v72
    v_cvt_pk_bf16_f32 v22, v24, v24
    v_lshlrev_b32 v24, 16, v22
    v_sub_f32 v25, 1.0, v111
    v_cvt_pk_bf16_f32 v22, v25, v25
    v_lshlrev_b32 v25, 16, v22
    v_mul_f32 v25, v25, v88
    v_cvt_pk_bf16_f32 v22, v25, v25
    v_lshlrev_b32 v25, 16, v22
    v_add_f32 v24, v24, v25
    v_cvt_pk_bf16_f32 v72, v24, v24
    v_lshlrev_b32 v25, 1, v1
    s_lshl_b32 s10, s81, 7
    buffer_store_short v40, v25, s[76:79], s10 offen
    buffer_store_short v72, v25, s[76:79], s10 offen offset:1280
L_end:
    s_endpgm
.section .rodata,"a"
.p2align 6
.amdhsa_kernel gated_mix__mha_block_cached__dense_activation_silu__decode_kernel
  .amdhsa_next_free_vgpr 256
  .amdhsa_next_free_sgpr 102
  .amdhsa_accum_offset 256
  .amdhsa_group_segment_fixed_size 0
  .amdhsa_kernarg_size 96
  .amdhsa_user_sgpr_count 2
  .amdhsa_user_sgpr_kernarg_segment_ptr 1
  .amdhsa_system_sgpr_workgroup_id_x 1
.end_amdhsa_kernel
```
